```python
import torch

def _softmax(x, axis=-1):
    return torch.softmax(x, dim=axis)
def _gelu(x):
    return torch.nn.functional.gelu(x, approximate="tanh")
def _silu(x):
    return torch.nn.functional.silu(x)
def _sigmoid(x):
    return torch.sigmoid(x)
def _layernorm(x, axis=-1, eps=1e-5):
    m = x.mean(dim=axis, keepdim=True)
    v = x.var(dim=axis, keepdim=True, unbiased=False)
    return (x - m) / torch.sqrt(v + eps)
def _scatter_add(tgt, idx, src, axis=0):
    return tgt.clone().index_add_(axis, idx, src)
def _segment_sum(src, seg, n):
    out = torch.zeros((n,) + src.shape[1:], dtype=src.dtype)
    return out.index_add_(0, seg, src)
def _pad(x, pw):
    flat = tuple(v for pair in reversed(pw) for v in pair)
    return torch.nn.functional.pad(x, flat)

kernel_name = 'gated_mix__linear_attn_block__mixer_s_mlp__prompt'

def setup_inputs():

    _w = (lambda a: (lambda t: t.to(torch.bfloat16) if t.is_floating_point() else t)(torch.as_tensor(a)))
    def _A_setup():
        B, S, D = 1, 2048, 640
        return {
            "x": _w((lambda *s: torch.randn(*s, dtype=torch.bfloat16) * 0.05)(B, S, D)),
            "wqkv": _w((lambda *s: torch.randn(*s, dtype=torch.bfloat16) * 3.2)(D, 3 * D)),
            "wo": _w((lambda *s: torch.randn(*s, dtype=torch.bfloat16) * 1.6)(D, D)),
        }
    _A_in = _A_setup()

    def _B_setup():
        B, S, D, F = 1, 2048, 640, 1728
        return {
            "x":  _w((lambda *s: torch.randn(*s, dtype=torch.bfloat16) * 0.05)(B, S, D)),
            "w1": _w((lambda *s: torch.randn(*s, dtype=torch.bfloat16) * 3.2)(D, D) * (D ** -0.5)),
            "w2": _w((lambda *s: torch.randn(*s, dtype=torch.bfloat16) * 3.2)(D, D) * (D ** -0.5)),
            "w3": _w((lambda *s: torch.randn(*s, dtype=torch.bfloat16) * 3.2)(D, F) * (D ** -0.5)),
            "w4": _w((lambda *s: torch.randn(*s, dtype=torch.bfloat16) * 3.2)(F, D) * (F ** -0.5)),
        }
    _B_in = _B_setup()

    return {
        "A_x": _A_in["x"],
        "A_wqkv": _A_in["wqkv"],
        "A_wo": _A_in["wo"],
        "B_x": _B_in["x"],
        "B_w1": _B_in["w1"],
        "B_w2": _B_in["w2"],
        "B_w3": _B_in["w3"],
        "B_w4": _B_in["w4"],
        "gate_w": _w((lambda *s: torch.randn(*s, dtype=torch.bfloat16) * 0.05)(640) * 16.0),
    }

def reference(A_x, A_wqkv, A_wo, B_x, B_w1, B_w2, B_w3, B_w4, gate_w):
    def _A_ref(x, wqkv, wo):
        B, S, D = x.shape
        H = 32; Dh = D // H
        qkv = (lambda x, *d: x.permute(*d))((x @ wqkv).reshape(B, S, 3, H, Dh), 2, 0, 3, 1, 4)
        q, k, v = qkv[0], qkv[1], qkv[2]
        phi = lambda t: torch.where(t > 0, t + 1, torch.exp(t)) + 1e-6
        pq, pk = phi(q), phi(k)
        kv = torch.einsum("bhsd,bhse->bhde", pk, v)
        z = torch.einsum("bhsd->bhd", pk)
        num = torch.einsum("bhqd,bhde->bhqe", pq, kv)
        den = torch.einsum("bhqd,bhd->bhq", pq, z)[..., None] + 1e-6
        o = num / den
        return (lambda x, *d: x.permute(*d))(o, 0, 2, 1, 3).reshape(B, S, D) @ wo

    def _B_ref(x, w1, w2, w3, w4):
        B, S, D = x.shape
        h = _gelu(_layernorm(x, axis=-1) @ w1)
        c = D // 4
        g0 = _pad(h[:, :, 0*c:1*c], ((0, 0), (1, 0), (0, 0)))[:, :S, :]
        g1 = _pad(h[:, :, 1*c:2*c], ((0, 0), (0, 1), (0, 0)))[:, 1:, :]
        g2 = _pad(h[:, :, 2*c:3*c], ((0, 0), (2, 0), (0, 0)))[:, :S, :]
        g3 = _pad(h[:, :, 3*c:   ], ((0, 0), (0, 2), (0, 0)))[:, 2:, :]
        hs = torch.concatenate([g0, g1, g2, g3], axis=-1) @ w2
        x1 = x + hs
        h2 = _gelu(_layernorm(x1, axis=-1) @ w3) @ w4
        return x1 + h2

    x = A_x
    g = _sigmoid((x * gate_w).sum(-1, keepdims=True))
    a = _A_ref(x, A_wqkv, A_wo)
    b = _B_ref(x, B_w1, B_w2, B_w3, B_w4)
    return g * a + (1 - g) * b
```

```asm
; @launch grid=(256,1,1) block=(512,1,1) lds=163840
.amdgcn_target "amdgcn-amd-amdhsa--gfx950"
.text
.globl gated_mix__linear_attn_block__mixer_s_mlp__prompt_kernel
.p2align 8
.type gated_mix__linear_attn_block__mixer_s_mlp__prompt_kernel,@function
gated_mix__linear_attn_block__mixer_s_mlp__prompt_kernel:
    s_cmp_ge_u32 s2, 256
    s_cbranch_scc1 L_k1_end
    v_mov_b32 v254, v0
    s_load_dwordx2 s[96:97], s[0:1], 80
    s_mov_b32 s98, 0
    s_mov_b32 s91, 0
    v_mov_b32 v4, 0
    v_mov_b32 v5, 0
    v_mov_b32 v6, 0
    v_mov_b32 v7, 0
    v_mov_b32 v8, 163712
    ds_write_b128 v8, v[4:7]
    ds_write_b128 v8, v[4:7] offset:16
    s_load_dwordx4 s[4:7], s[0:1], 0
    s_load_dwordx2 s[10:11], s[0:1], 32
    s_load_dwordx2 s[12:13], s[0:1], 88
    v_lshrrev_b32 v1, 6, v0
    v_and_b32 v0, 63, v0
    s_and_b32 s16, s2, 7
    s_lshr_b32 s17, s2, 3
    v_readfirstlane_b32 s22, v1
    s_and_b32 s18, s16, 3
    s_lshr_b32 s19, s16, 2
    s_lshl_b32 s19, s19, 3
    s_and_b32 s20, s17, 7
    s_add_u32 s20, s20, s19
    s_lshr_b32 s21, s17, 3
    s_lshl_b32 s3, s18, 2
    s_add_u32 s3, s3, s21
    s_mov_b32 s19, s21
    s_lshl_b32 s3, s18, 1
    s_add_u32 s3, s3, s19
    s_mov_b32 s21, s18
    s_cmp_lt_u32 s19, 2
    s_cselect_b32 s18, 0, s19
    s_cmp_lt_u32 s22, 4
    s_cbranch_scc1 L_k1_compute
    s_sub_u32 s22, s22, 4
    s_setprio 0
    v_lshrrev_b32 v11, 3, v0
    v_mul_u32_u24 v11, 1280, v11
    v_lshrrev_b32 v12, 4, v0
    v_and_b32 v13, 7, v0
    v_xor_b32 v12, v12, v13
    v_lshl_add_u32 v11, v12, 4, v11
    s_lshl_b32 s36, s20, 7
    s_lshl_b32 s37, s22, 5
    s_add_u32 s36, s36, s37
    s_mul_i32 s36, s36, 1280
    v_add_u32 v2, s36, v11
    v_xor_b32 v12, 64, v11
    s_add_u32 s37, s36, 9216
    v_add_u32 v3, s37, v12
    s_add_u32 s37, s36, 18432
    v_add_u32 v4, s37, v11
    s_add_u32 s37, s36, 27648
    v_add_u32 v5, s37, v12
    s_mul_i32 s23, s3, 160
    s_add_u32 s23, s23, 1280
    s_mul_i32 s16, s21, 320
    s_cmp_lt_u32 s18, 2
    s_cselect_b32 s23, s23, s16
    s_cmp_eq_u32 s18, 3
    s_mov_b32 s15, 3840
    s_cselect_b32 s15, 1280, s15
    s_and_b32 s49, s20, 7
    s_mul_i32 s36, s19, 3
    s_add_u32 s49, s49, s36
    s_cmp_ge_u32 s49, 10
    s_cselect_b32 s36, 10, 0
    s_sub_u32 s49, s49, s36
    s_mul_i32 s49, s49, 1
    s_lshl_b32 s41, s15, 6
    s_lshl_b32 s42, s22, 12
    s_mul_i32 s43, s22, 5120
    s_add_u32 s43, s43, 61440
    s_lshl_b32 s36, s49, 7
    s_mul_i32 s37, s49, s41
    v_lshrrev_b32 v11, 2, v0
    s_lshl_b32 s44, s22, 4
    v_add_u32 v11, s44, v11
    v_mul_lo_u32 v11, v11, s15
    v_lshrrev_b32 v12, 5, v0
    v_lshlrev_b32 v12, 1, v12
    v_and_b32 v13, 3, v0
    v_xor_b32 v12, v12, v13
    v_and_b32 v13, 1, v12
    v_lshrrev_b32 v12, 1, v12
    v_lshl_add_u32 v11, v13, 4, v11
    v_add_u32 v11, s23, v11
    s_cmp_lt_u32 s18, 2
    s_mov_b32 s44, 0
    s_cselect_b32 s44, 0, s44
    s_mov_b32 s45, 32
    s_cselect_b32 s45, 0x20, s45
    v_mad_i32_i24 v6, v12, s45, v11
    v_add_u32 v6, s44, v6
    s_mov_b32 s44, 64
    s_cselect_b32 s44, 64, s44
    s_mov_b32 s45, 32
    s_cselect_b32 s45, 0x4c0, s45
    v_mad_i32_i24 v7, v12, s45, v11
    v_add_u32 v7, s44, v7
    s_mov_b32 s44, 128
    s_cselect_b32 s44, 1312, s44
    s_mov_b32 s45, 32
    s_cselect_b32 s45, 0xfffffb40, s45
    v_mad_i32_i24 v8, v12, s45, v11
    v_add_u32 v8, s44, v8
    s_mov_b32 s44, 192
    s_cselect_b32 s44, 128, s44
    s_mov_b32 s45, 32
    s_cselect_b32 s45, 0x4c0, s45
    v_mad_i32_i24 v9, v12, s45, v11
    v_add_u32 v9, s44, v9
    s_mov_b32 s44, 256
    s_cselect_b32 s44, 1376, s44
    s_mov_b32 s45, 32
    s_cselect_b32 s45, 0x20, s45
    v_mad_i32_i24 v10, v12, s45, v11
    v_add_u32 v10, s44, v10
    s_waitcnt lgkmcnt(0)
    s_mov_b32 s32, s12
    s_mov_b32 s33, s13
    s_mov_b32 s34, 23379968
    s_mov_b32 s35, 0x20000
    s_mov_b32 s24, s4
    s_mov_b32 s25, s5
    s_mov_b32 s26, 2621440
    s_mov_b32 s27, 0x20000
    s_cmp_eq_u32 s18, 3
    s_cselect_b64 s[6:7], s[10:11], s[6:7]
    s_mov_b32 s30, 2457600
    s_cselect_b32 s30, 819200, s30
    s_mov_b32 s28, s6
    s_mov_b32 s29, s7
    s_mov_b32 s31, 0x20000
    s_mov_b32 s40, 0
    s_mov_b32 s50, 0
    s_mov_b32 s44, 0
L_k1_ld_pro:
    s_lshl_b32 s38, s50, 14
    s_add_u32 s38, s38, s42
    s_mul_i32 s39, s40, 20480
    s_add_u32 s39, s39, s43
    s_mov_b32 m0, s38
    s_add_u32 s40, s40, 1
    buffer_load_dwordx4 v2, s[24:27], s36 offen offset:0 lds
    buffer_load_dwordx4 v3, s[24:27], s36 offen offset:1024 lds
    buffer_load_dwordx4 v4, s[24:27], s36 offen offset:2048 lds
    buffer_load_dwordx4 v5, s[24:27], s36 offen offset:3072 lds
    s_mov_b32 m0, s39
    s_and_b32 s40, s40, 3
    buffer_load_dwordx4 v6, s[28:31], s37 offen lds
    s_add_u32 m0, m0, 1024
    s_nop 0
    buffer_load_dwordx4 v7, s[28:31], s37 offen lds
    s_add_u32 m0, m0, 1024
    s_nop 0
    buffer_load_dwordx4 v8, s[28:31], s37 offen lds
    s_add_u32 m0, m0, 1024
    s_nop 0
    buffer_load_dwordx4 v9, s[28:31], s37 offen lds
    s_add_u32 m0, m0, 1024
    s_nop 0
    buffer_load_dwordx4 v10, s[28:31], s37 offen lds
    s_add_u32 s36, s36, 128
    s_add_u32 s37, s37, s41
    s_add_u32 s49, s49, 1
    s_cmp_eq_u32 s49, 10
    s_cselect_b32 s36, 0, s36
    s_cselect_b32 s37, 0, s37
    s_cselect_b32 s49, 0, s49
    s_add_u32 s50, s50, 1
    s_cmp_eq_u32 s50, 3
    s_cselect_b32 s50, 0, s50
    s_add_u32 s44, s44, 1
    s_cmp_lt_u32 s44, 2
    s_cbranch_scc1 L_k1_ld_pro
    s_mov_b32 s44, 0
L_k1_ld_loop:
    s_waitcnt vmcnt(9)
    s_barrier
    s_lshl_b32 s38, s50, 14
    s_add_u32 s38, s38, s42
    s_mul_i32 s39, s40, 20480
    s_add_u32 s39, s39, s43
    s_mov_b32 m0, s38
    s_add_u32 s40, s40, 1
    buffer_load_dwordx4 v2, s[24:27], s36 offen offset:0 lds
    buffer_load_dwordx4 v3, s[24:27], s36 offen offset:1024 lds
    buffer_load_dwordx4 v4, s[24:27], s36 offen offset:2048 lds
    buffer_load_dwordx4 v5, s[24:27], s36 offen offset:3072 lds
    s_mov_b32 m0, s39
    s_and_b32 s40, s40, 3
    buffer_load_dwordx4 v6, s[28:31], s37 offen lds
    s_add_u32 m0, m0, 1024
    s_nop 0
    buffer_load_dwordx4 v7, s[28:31], s37 offen lds
    s_add_u32 m0, m0, 1024
    s_nop 0
    buffer_load_dwordx4 v8, s[28:31], s37 offen lds
    s_add_u32 m0, m0, 1024
    s_nop 0
    buffer_load_dwordx4 v9, s[28:31], s37 offen lds
    s_add_u32 m0, m0, 1024
    s_nop 0
    buffer_load_dwordx4 v10, s[28:31], s37 offen lds
    s_add_u32 s36, s36, 128
    s_add_u32 s37, s37, s41
    s_add_u32 s49, s49, 1
    s_cmp_eq_u32 s49, 10
    s_cselect_b32 s36, 0, s36
    s_cselect_b32 s37, 0, s37
    s_cselect_b32 s49, 0, s49
    s_add_u32 s50, s50, 1
    s_cmp_eq_u32 s50, 3
    s_cselect_b32 s50, 0, s50
    s_add_u32 s44, s44, 1
    s_cmp_lt_u32 s44, 8
    s_cbranch_scc1 L_k1_ld_loop
    s_waitcnt vmcnt(9)
    s_barrier
    s_waitcnt vmcnt(0)
    s_barrier
    s_barrier
    s_branch L_phase2
L_k1_compute:
    v_mov_b32 v255, v0
    s_mov_b32 s61, 0
    s_setprio 0
    s_lshr_b32 s36, s22, 1
    s_and_b32 s37, s22, 1
    v_and_b32 v160, 15, v255
    v_lshrrev_b32 v161, 4, v255
    v_lshrrev_b32 v162, 1, v160
    v_xor_b32 v162, v162, v161
    v_lshlrev_b32 v162, 4, v162
    v_lshl_add_u32 v162, v160, 7, v162
    s_lshl_b32 s38, s36, 13
    v_add_u32 v152, s38, v162
    v_xor_b32 v153, 64, v152
    v_lshrrev_b32 v162, 1, v161
    v_mul_u32_u24 v162, 5120, v162
    v_and_b32 v163, 1, v161
    v_lshrrev_b32 v164, 2, v160
    v_lshl_add_u32 v164, v163, 3, v164
    v_lshl_add_u32 v162, v164, 6, v162
    v_and_b32 v164, 3, v160
    v_lshl_add_u32 v162, v164, 3, v162
    v_add_u32 v162, 61440, v162
    v_lshl_add_u32 v164, v163, 5, v162
    v_xor_b32 v163, 1, v163
    v_lshl_add_u32 v165, v163, 5, v162
    s_cmp_eq_u32 s37, 0
    s_cbranch_scc0 L_k1_c_wn1
    v_mov_b32 v154, v164
    v_mov_b32 v155, v165
    s_branch L_k1_c_wn
L_k1_c_wn1:
    v_add_u32 v154, 0x800, v165
    v_add_u32 v155, 0xc00, v164
L_k1_c_wn:
    v_mov_b32 v0, 0
    v_mov_b32 v1, 0
    v_mov_b32 v2, 0
    v_mov_b32 v3, 0
    v_mov_b32 v4, 0
    v_mov_b32 v5, 0
    v_mov_b32 v6, 0
    v_mov_b32 v7, 0
    v_mov_b32 v8, 0
    v_mov_b32 v9, 0
    v_mov_b32 v10, 0
    v_mov_b32 v11, 0
    v_mov_b32 v12, 0
    v_mov_b32 v13, 0
    v_mov_b32 v14, 0
    v_mov_b32 v15, 0
    v_mov_b32 v16, 0
    v_mov_b32 v17, 0
    v_mov_b32 v18, 0
    v_mov_b32 v19, 0
    v_mov_b32 v20, 0
    v_mov_b32 v21, 0
    v_mov_b32 v22, 0
    v_mov_b32 v23, 0
    v_mov_b32 v24, 0
    v_mov_b32 v25, 0
    v_mov_b32 v26, 0
    v_mov_b32 v27, 0
    v_mov_b32 v28, 0
    v_mov_b32 v29, 0
    v_mov_b32 v30, 0
    v_mov_b32 v31, 0
    v_mov_b32 v32, 0
    v_mov_b32 v33, 0
    v_mov_b32 v34, 0
    v_mov_b32 v35, 0
    v_mov_b32 v36, 0
    v_mov_b32 v37, 0
    v_mov_b32 v38, 0
    v_mov_b32 v39, 0
    v_mov_b32 v40, 0
    v_mov_b32 v41, 0
    v_mov_b32 v42, 0
    v_mov_b32 v43, 0
    v_mov_b32 v44, 0
    v_mov_b32 v45, 0
    v_mov_b32 v46, 0
    v_mov_b32 v47, 0
    v_mov_b32 v48, 0
    v_mov_b32 v49, 0
    v_mov_b32 v50, 0
    v_mov_b32 v51, 0
    v_mov_b32 v52, 0
    v_mov_b32 v53, 0
    v_mov_b32 v54, 0
    v_mov_b32 v55, 0
    v_mov_b32 v56, 0
    v_mov_b32 v57, 0
    v_mov_b32 v58, 0
    v_mov_b32 v59, 0
    v_mov_b32 v60, 0
    v_mov_b32 v61, 0
    v_mov_b32 v62, 0
    v_mov_b32 v63, 0
    v_mov_b32 v64, 0
    v_mov_b32 v65, 0
    v_mov_b32 v66, 0
    v_mov_b32 v67, 0
    v_mov_b32 v68, 0
    v_mov_b32 v69, 0
    v_mov_b32 v70, 0
    v_mov_b32 v71, 0
    v_mov_b32 v72, 0
    v_mov_b32 v73, 0
    v_mov_b32 v74, 0
    v_mov_b32 v75, 0
    v_mov_b32 v76, 0
    v_mov_b32 v77, 0
    v_mov_b32 v78, 0
    v_mov_b32 v79, 0
    s_waitcnt lgkmcnt(0)
    s_mov_b32 s32, s12
    s_mov_b32 s33, s13
    s_mov_b32 s34, 23379968
    s_mov_b32 s35, 0x20000
    s_cmp_eq_u32 s22, 0
    s_cbranch_scc0 L_cz0_1
    s_add_u32 s92, s12, 23379968
    s_addc_u32 s93, s13, 0
    s_mov_b32 s94, 40960
    s_mov_b32 s95, 0x20000
    s_lshl_b32 s99, s2, 7
    s_add_u32 s99, s99, 8192
    v_mov_b32 v170, s99
    v_mov_b32 v172, 0
    v_mov_b32 v173, 0
    v_mov_b32 v174, 0
    v_mov_b32 v175, 0
    s_mov_b64 exec, 1
    buffer_store_dwordx4 v[172:175], v170, s[92:95], 0 offen sc1
    s_cmp_lt_u32 s2, 40
    s_cbranch_scc0 L_cz_2
    s_lshl_b32 s99, s2, 7
    v_mov_b32 v170, s99
    buffer_store_dword v172, v170, s[92:95], 0 offen sc1
L_cz_2:
    s_mov_b64 exec, -1
L_cz0_1:
    s_cmp_eq_u32 s22, 1
    s_cbranch_scc0 L_cp0_3
    s_getpc_b64 s[92:93]
L_pc_4:
    s_sub_u32 s92, s92, L_pc_4-gated_mix__linear_attn_block__mixer_s_mlp__prompt_kernel
    s_subb_u32 s93, s93, 0
    s_mov_b32 s94, L_code_end-gated_mix__linear_attn_block__mixer_s_mlp__prompt_kernel
    s_mov_b32 s95, 0x20000
    s_lshr_b32 s99, s2, 3
    s_lshl_b32 s99, s99, 11
    v_and_b32 v248, 63, v254
    v_lshlrev_b32 v248, 5, v248
    v_add_u32 v248, s99, v248
    buffer_load_dword v249, v248, s[92:95], 0 offen
L_cp0_3:
    s_cmp_eq_u32 s22, 2
    s_cbranch_scc0 L_tw0_5
L_tw0_5:
    s_cmp_lt_u32 s18, 2
    s_cbranch_scc1 L_k1_kv
    v_lshrrev_b32 v161, 4, v255
    v_and_b32 v160, 15, v255
    v_lshlrev_b32 v160, 4, v160
    v_and_b32 v162, 1, v161
    v_lshrrev_b32 v163, 1, v161
    v_lshl_add_u32 v164, v162, 1, v163
    v_lshl_add_u32 v156, v164, 15, v160
    v_add_u32 v163, 8, v163
    v_lshl_add_u32 v163, v163, 15, v160
    v_lshl_add_u32 v157, v162, 3, v163
    s_mul_i32 s38, s21, 20
    s_mul_i32 s39, s37, 10
    s_add_u32 s38, s38, s39
    s_lshl_b32 s38, s38, 15
    s_lshl_b32 s39, s20, 7
    s_lshl_b32 s42, s36, 6
    s_add_u32 s39, s39, s42
    s_lshl_b32 s39, s39, 4
    s_add_u32 s38, s38, s39
    s_cmp_eq_u32 s18, 3
    s_cselect_b32 s39, 2621440, 0
    s_add_u32 s38, s38, s39
    v_add_u32 v156, s38, v156
    v_add_u32 v157, s38, v157
    s_mov_b32 s60, 131072
    s_mov_b32 s46, 0
    s_mov_b32 s47, 0
    v_mov_b32 v158, 0x3fb8aa3b
    v_mov_b32 v159, 0
    s_mov_b32 s44, 0x358637bd
    s_cmp_eq_u32 s18, 3
    s_cbranch_scc0 L_k1_q_main
    v_and_b32 v162, 15, v255
    v_lshlrev_b32 v162, 3, v162
    s_lshl_b32 s42, s22, 9
    v_add_u32 v172, s42, v162
    s_xor_b32 s42, s42, 512
    v_add_u32 v174, s42, v162
    v_lshrrev_b32 v164, 4, v255
    v_lshlrev_b32 v164, 4, v164
    s_mul_i32 s42, s22, 320
    v_add_u32 v173, s42, v164
    s_xor_b32 s42, s22, 2
    s_mul_i32 s42, s42, 320
    v_add_u32 v175, s42, v164
    v_and_b32 v166, 3, v255
    v_bfe_u32 v167, v255, 2, 2
    v_lshrrev_b32 v168, 4, v255
    v_cmp_eq_u32 s[52:53], 1, v166
    v_cmp_eq_u32 s[54:55], 2, v166
    v_cmp_eq_u32 s[56:57], 3, v166
    v_cmp_eq_u32 s[58:59], v167, v168
    v_mov_b32 v232, 0
    v_mov_b32 v233, 0
    v_mov_b32 v234, 0
    v_mov_b32 v235, 0
    v_mov_b32 v236, 0
    v_mov_b32 v237, 0
    v_mov_b32 v238, 0
    v_mov_b32 v239, 0
    v_mov_b32 v240, 0
    v_mov_b32 v241, 0
    v_mov_b32 v242, 0
    v_mov_b32 v243, 0
    v_mov_b32 v244, 0
    v_mov_b32 v245, 0
    v_mov_b32 v246, 0
    v_mov_b32 v247, 0
    v_mov_b32 v180, 0
    v_mov_b32 v181, 0
    v_mov_b32 v182, 0
    v_mov_b32 v183, 0
    v_mov_b32 v184, 0
    v_mov_b32 v185, 0
    v_mov_b32 v186, 0
    v_mov_b32 v187, 0
    v_mov_b32 v188, 0
    v_mov_b32 v189, 0
    v_mov_b32 v190, 0
    v_mov_b32 v191, 0
    v_mov_b32 v192, 0
    v_mov_b32 v193, 0
    v_mov_b32 v194, 0
    v_mov_b32 v195, 0
    v_mov_b32 v208, 0
    v_mov_b32 v209, 0
    v_mov_b32 v210, 0
    v_mov_b32 v211, 0
    v_mov_b32 v212, 0
    v_mov_b32 v213, 0
    v_mov_b32 v214, 0
    v_mov_b32 v215, 0
    v_mov_b32 v216, 0
    v_mov_b32 v217, 0
    v_mov_b32 v218, 0
    v_mov_b32 v219, 0
    v_mov_b32 v220, 0
    v_mov_b32 v221, 0
    v_mov_b32 v222, 0
    v_mov_b32 v223, 0
    v_mov_b32 v224, 0
    v_mov_b32 v225, 0
    v_mov_b32 v226, 0
    v_mov_b32 v227, 0
    v_mov_b32 v228, 0x3f803f80
    v_mov_b32 v229, 0x3f803f80
    v_mov_b32 v230, 0x3f803f80
    v_mov_b32 v231, 0x3f803f80
    s_xor_b32 s38, s36, s37
    s_cmp_eq_u32 s38, 0
    s_cbranch_scc0 L_k1_h_main1
    s_mov_b32 s40, 0
    s_mov_b32 s51, 0
    s_barrier
    ds_read_b64_tr_b16 v[96:97], v154 offset:0
    ds_read_b64_tr_b16 v[98:99], v154 offset:256
    ds_read_b128 v[80:83], v152 offset:0
    ds_read_b128 v[84:87], v152 offset:2048
    ds_read_b128 v[88:91], v152 offset:4096
    ds_read_b128 v[92:95], v152 offset:6144
    ds_read_b64_tr_b16 v[100:101], v155 offset:0
    ds_read_b64_tr_b16 v[102:103], v155 offset:256
    ds_read_b64_tr_b16 v[104:105], v154 offset:1024
    ds_read_b64_tr_b16 v[106:107], v154 offset:1280
    ds_read_b64_tr_b16 v[108:109], v155 offset:1024
    ds_read_b64_tr_b16 v[110:111], v155 offset:1280
    ds_read_b64_tr_b16 v[112:113], v154 offset:2048
    ds_read_b64_tr_b16 v[114:115], v154 offset:2304
    s_waitcnt lgkmcnt(0)
L_k1_main_h0:
    v_mfma_f32_16x16x32_bf16 v[0:3], v[96:99], v[80:83], v[0:3]
    ds_read_b64_tr_b16 v[132:133], v154 offset:10240
    v_mfma_f32_16x16x32_bf16 v[20:23], v[96:99], v[84:87], v[20:23]
    ds_read_b64_tr_b16 v[134:135], v154 offset:10496
    v_mfma_f32_16x16x32_bf16 v[40:43], v[96:99], v[88:91], v[40:43]
    ds_read_b128 v[116:119], v153 offset:0
    v_mfma_f32_16x16x32_bf16 v[60:63], v[96:99], v[92:95], v[60:63]
    ds_read_b128 v[120:123], v153 offset:2048
    v_mfma_f32_16x16x32_bf16 v[4:7], v[100:103], v[80:83], v[4:7]
    ds_read_b128 v[124:127], v153 offset:4096
    v_mfma_f32_16x16x32_bf16 v[24:27], v[100:103], v[84:87], v[24:27]
    ds_read_b128 v[128:131], v153 offset:6144
    v_mfma_f32_16x16x32_bf16 v[44:47], v[100:103], v[88:91], v[44:47]
    ds_read_b64_tr_b16 v[136:137], v155 offset:10240
    v_mfma_f32_16x16x32_bf16 v[64:67], v[100:103], v[92:95], v[64:67]
    ds_read_b64_tr_b16 v[138:139], v155 offset:10496
    v_mfma_f32_16x16x32_bf16 v[8:11], v[104:107], v[80:83], v[8:11]
    ds_read_b64_tr_b16 v[140:141], v154 offset:11264
    v_mfma_f32_16x16x32_bf16 v[28:31], v[104:107], v[84:87], v[28:31]
    ds_read_b64_tr_b16 v[142:143], v154 offset:11520
    v_mfma_f32_16x16x32_bf16 v[48:51], v[104:107], v[88:91], v[48:51]
    ds_read_b64_tr_b16 v[144:145], v155 offset:11264
    v_mfma_f32_16x16x32_bf16 v[68:71], v[104:107], v[92:95], v[68:71]
    ds_read_b64_tr_b16 v[146:147], v155 offset:11520
    v_mfma_f32_16x16x32_bf16 v[12:15], v[108:111], v[80:83], v[12:15]
    ds_read_b64_tr_b16 v[148:149], v154 offset:12288
    v_mfma_f32_16x16x32_bf16 v[32:35], v[108:111], v[84:87], v[32:35]
    ds_read_b64_tr_b16 v[150:151], v154 offset:12544
    s_add_u32 s40, s40, 1
    s_and_b32 s41, s40, 3
    v_mfma_f32_16x16x32_bf16 v[52:55], v[108:111], v[88:91], v[52:55]
    s_add_u32 s51, s51, 1
    s_movk_i32 s42, 16384
    v_mfma_f32_16x16x32_bf16 v[72:75], v[108:111], v[92:95], v[72:75]
    s_movk_i32 s43, 20480
    s_cmp_eq_u32 s41, 0
    v_mfma_f32_16x16x32_bf16 v[16:19], v[112:115], v[80:83], v[16:19]
    s_cselect_b32 s43, 0xffff1000, s43
    s_cmp_eq_u32 s51, 3
    v_mfma_f32_16x16x32_bf16 v[36:39], v[112:115], v[84:87], v[36:39]
    s_cselect_b32 s42, 0xffff8000, s42
    s_cselect_b32 s51, 0, s51
    v_mfma_f32_16x16x32_bf16 v[56:59], v[112:115], v[88:91], v[56:59]
    v_add_u32 v152, s42, v152
    v_add_u32 v153, s42, v153
    v_mfma_f32_16x16x32_bf16 v[76:79], v[112:115], v[92:95], v[76:79]
    v_add_u32 v154, s43, v154
    v_add_u32 v155, s43, v155
    v_mfma_f32_16x16x32_bf16 v[232:235], v[228:231], v[80:83], v[232:235]
    s_cmp_eq_u32 s40, 10
    v_mfma_f32_16x16x32_bf16 v[180:183], v[80:83], v[80:83], v[180:183]
    v_mfma_f32_16x16x32_bf16 v[236:239], v[228:231], v[84:87], v[236:239]
    v_mfma_f32_16x16x32_bf16 v[184:187], v[84:87], v[84:87], v[184:187]
    v_mfma_f32_16x16x32_bf16 v[240:243], v[228:231], v[88:91], v[240:243]
    v_mfma_f32_16x16x32_bf16 v[188:191], v[88:91], v[88:91], v[188:191]
    v_mfma_f32_16x16x32_bf16 v[244:247], v[228:231], v[92:95], v[244:247]
    v_mfma_f32_16x16x32_bf16 v[192:195], v[92:95], v[92:95], v[192:195]
    s_waitcnt lgkmcnt(0)
    s_cbranch_scc1 L_k1_nobar_h0
    s_barrier
L_k1_nobar_h0:
    v_mfma_f32_16x16x32_bf16 v[0:3], v[132:135], v[116:119], v[0:3]
    ds_read_b64_tr_b16 v[96:97], v154 offset:0
    v_mfma_f32_16x16x32_bf16 v[20:23], v[132:135], v[120:123], v[20:23]
    ds_read_b64_tr_b16 v[98:99], v154 offset:256
    v_mfma_f32_16x16x32_bf16 v[40:43], v[132:135], v[124:127], v[40:43]
    ds_read_b128 v[80:83], v152 offset:0
    v_mfma_f32_16x16x32_bf16 v[60:63], v[132:135], v[128:131], v[60:63]
    ds_read_b128 v[84:87], v152 offset:2048
    v_mfma_f32_16x16x32_bf16 v[4:7], v[136:139], v[116:119], v[4:7]
    ds_read_b128 v[88:91], v152 offset:4096
    v_mfma_f32_16x16x32_bf16 v[24:27], v[136:139], v[120:123], v[24:27]
    ds_read_b128 v[92:95], v152 offset:6144
    v_mfma_f32_16x16x32_bf16 v[44:47], v[136:139], v[124:127], v[44:47]
    ds_read_b64_tr_b16 v[100:101], v155 offset:0
    v_mfma_f32_16x16x32_bf16 v[64:67], v[136:139], v[128:131], v[64:67]
    ds_read_b64_tr_b16 v[102:103], v155 offset:256
    v_mfma_f32_16x16x32_bf16 v[8:11], v[140:143], v[116:119], v[8:11]
    ds_read_b64_tr_b16 v[104:105], v154 offset:1024
    v_mfma_f32_16x16x32_bf16 v[28:31], v[140:143], v[120:123], v[28:31]
    ds_read_b64_tr_b16 v[106:107], v154 offset:1280
    v_mfma_f32_16x16x32_bf16 v[48:51], v[140:143], v[124:127], v[48:51]
    ds_read_b64_tr_b16 v[108:109], v155 offset:1024
    v_mfma_f32_16x16x32_bf16 v[68:71], v[140:143], v[128:131], v[68:71]
    ds_read_b64_tr_b16 v[110:111], v155 offset:1280
    v_mfma_f32_16x16x32_bf16 v[12:15], v[144:147], v[116:119], v[12:15]
    ds_read_b64_tr_b16 v[112:113], v154 offset:2048
    v_mfma_f32_16x16x32_bf16 v[32:35], v[144:147], v[120:123], v[32:35]
    ds_read_b64_tr_b16 v[114:115], v154 offset:2304
    v_mfma_f32_16x16x32_bf16 v[52:55], v[144:147], v[124:127], v[52:55]
    v_mfma_f32_16x16x32_bf16 v[72:75], v[144:147], v[128:131], v[72:75]
    v_mfma_f32_16x16x32_bf16 v[16:19], v[148:151], v[116:119], v[16:19]
    v_mfma_f32_16x16x32_bf16 v[36:39], v[148:151], v[120:123], v[36:39]
    v_mfma_f32_16x16x32_bf16 v[56:59], v[148:151], v[124:127], v[56:59]
    v_mfma_f32_16x16x32_bf16 v[76:79], v[148:151], v[128:131], v[76:79]
    v_mfma_f32_16x16x32_bf16 v[208:211], v[132:135], v[228:231], v[208:211]
    v_mfma_f32_16x16x32_bf16 v[212:215], v[136:139], v[228:231], v[212:215]
    v_mfma_f32_16x16x32_bf16 v[216:219], v[140:143], v[228:231], v[216:219]
    v_mfma_f32_16x16x32_bf16 v[220:223], v[144:147], v[228:231], v[220:223]
    v_mfma_f32_16x16x32_bf16 v[224:227], v[148:151], v[228:231], v[224:227]
    s_waitcnt lgkmcnt(0)
    s_cbranch_scc0 L_k1_main_h0
    s_barrier
    s_branch L_k1_qh_epi
L_k1_h_main1:
    s_mov_b32 s40, 0
    s_mov_b32 s51, 0
    s_barrier
    ds_read_b64_tr_b16 v[96:97], v154 offset:0
    ds_read_b64_tr_b16 v[98:99], v154 offset:256
    ds_read_b128 v[80:83], v152 offset:0
    ds_read_b128 v[84:87], v152 offset:2048
    ds_read_b128 v[88:91], v152 offset:4096
    ds_read_b128 v[92:95], v152 offset:6144
    ds_read_b64_tr_b16 v[100:101], v155 offset:0
    ds_read_b64_tr_b16 v[102:103], v155 offset:256
    ds_read_b64_tr_b16 v[104:105], v154 offset:1024
    ds_read_b64_tr_b16 v[106:107], v154 offset:1280
    ds_read_b64_tr_b16 v[108:109], v155 offset:1024
    ds_read_b64_tr_b16 v[110:111], v155 offset:1280
    ds_read_b64_tr_b16 v[112:113], v154 offset:2048
    ds_read_b64_tr_b16 v[114:115], v154 offset:2304
    s_waitcnt lgkmcnt(0)
L_k1_main_h1:
    v_mfma_f32_16x16x32_bf16 v[0:3], v[96:99], v[80:83], v[0:3]
    ds_read_b64_tr_b16 v[132:133], v154 offset:10240
    v_mfma_f32_16x16x32_bf16 v[20:23], v[96:99], v[84:87], v[20:23]
    ds_read_b64_tr_b16 v[134:135], v154 offset:10496
    v_mfma_f32_16x16x32_bf16 v[40:43], v[96:99], v[88:91], v[40:43]
    ds_read_b128 v[116:119], v153 offset:0
    v_mfma_f32_16x16x32_bf16 v[60:63], v[96:99], v[92:95], v[60:63]
    ds_read_b128 v[120:123], v153 offset:2048
    v_mfma_f32_16x16x32_bf16 v[4:7], v[100:103], v[80:83], v[4:7]
    ds_read_b128 v[124:127], v153 offset:4096
    v_mfma_f32_16x16x32_bf16 v[24:27], v[100:103], v[84:87], v[24:27]
    ds_read_b128 v[128:131], v153 offset:6144
    v_mfma_f32_16x16x32_bf16 v[44:47], v[100:103], v[88:91], v[44:47]
    ds_read_b64_tr_b16 v[136:137], v155 offset:10240
    v_mfma_f32_16x16x32_bf16 v[64:67], v[100:103], v[92:95], v[64:67]
    ds_read_b64_tr_b16 v[138:139], v155 offset:10496
    v_mfma_f32_16x16x32_bf16 v[8:11], v[104:107], v[80:83], v[8:11]
    ds_read_b64_tr_b16 v[140:141], v154 offset:11264
    v_mfma_f32_16x16x32_bf16 v[28:31], v[104:107], v[84:87], v[28:31]
    ds_read_b64_tr_b16 v[142:143], v154 offset:11520
    v_mfma_f32_16x16x32_bf16 v[48:51], v[104:107], v[88:91], v[48:51]
    ds_read_b64_tr_b16 v[144:145], v155 offset:11264
    v_mfma_f32_16x16x32_bf16 v[68:71], v[104:107], v[92:95], v[68:71]
    ds_read_b64_tr_b16 v[146:147], v155 offset:11520
    v_mfma_f32_16x16x32_bf16 v[12:15], v[108:111], v[80:83], v[12:15]
    ds_read_b64_tr_b16 v[148:149], v154 offset:12288
    v_mfma_f32_16x16x32_bf16 v[32:35], v[108:111], v[84:87], v[32:35]
    ds_read_b64_tr_b16 v[150:151], v154 offset:12544
    s_add_u32 s40, s40, 1
    s_and_b32 s41, s40, 3
    v_mfma_f32_16x16x32_bf16 v[52:55], v[108:111], v[88:91], v[52:55]
    s_add_u32 s51, s51, 1
    s_movk_i32 s42, 16384
    v_mfma_f32_16x16x32_bf16 v[72:75], v[108:111], v[92:95], v[72:75]
    s_movk_i32 s43, 20480
    s_cmp_eq_u32 s41, 0
    v_mfma_f32_16x16x32_bf16 v[16:19], v[112:115], v[80:83], v[16:19]
    s_cselect_b32 s43, 0xffff1000, s43
    s_cmp_eq_u32 s51, 3
    v_mfma_f32_16x16x32_bf16 v[36:39], v[112:115], v[84:87], v[36:39]
    s_cselect_b32 s42, 0xffff8000, s42
    s_cselect_b32 s51, 0, s51
    v_mfma_f32_16x16x32_bf16 v[56:59], v[112:115], v[88:91], v[56:59]
    v_add_u32 v152, s42, v152
    v_add_u32 v153, s42, v153
    v_mfma_f32_16x16x32_bf16 v[76:79], v[112:115], v[92:95], v[76:79]
    v_add_u32 v154, s43, v154
    v_add_u32 v155, s43, v155
    v_mfma_f32_16x16x32_bf16 v[208:211], v[96:99], v[228:231], v[208:211]
    s_cmp_eq_u32 s40, 10
    v_mfma_f32_16x16x32_bf16 v[212:215], v[100:103], v[228:231], v[212:215]
    v_mfma_f32_16x16x32_bf16 v[216:219], v[104:107], v[228:231], v[216:219]
    v_mfma_f32_16x16x32_bf16 v[220:223], v[108:111], v[228:231], v[220:223]
    v_mfma_f32_16x16x32_bf16 v[224:227], v[112:115], v[228:231], v[224:227]
    s_waitcnt lgkmcnt(0)
    s_cbranch_scc1 L_k1_nobar_h1
    s_barrier
L_k1_nobar_h1:
    v_mfma_f32_16x16x32_bf16 v[0:3], v[132:135], v[116:119], v[0:3]
    ds_read_b64_tr_b16 v[96:97], v154 offset:0
    v_mfma_f32_16x16x32_bf16 v[20:23], v[132:135], v[120:123], v[20:23]
    ds_read_b64_tr_b16 v[98:99], v154 offset:256
    v_mfma_f32_16x16x32_bf16 v[40:43], v[132:135], v[124:127], v[40:43]
    ds_read_b128 v[80:83], v152 offset:0
    v_mfma_f32_16x16x32_bf16 v[60:63], v[132:135], v[128:131], v[60:63]
    ds_read_b128 v[84:87], v152 offset:2048
    v_mfma_f32_16x16x32_bf16 v[4:7], v[136:139], v[116:119], v[4:7]
    ds_read_b128 v[88:91], v152 offset:4096
    v_mfma_f32_16x16x32_bf16 v[24:27], v[136:139], v[120:123], v[24:27]
    ds_read_b128 v[92:95], v152 offset:6144
    v_mfma_f32_16x16x32_bf16 v[44:47], v[136:139], v[124:127], v[44:47]
    ds_read_b64_tr_b16 v[100:101], v155 offset:0
    v_mfma_f32_16x16x32_bf16 v[64:67], v[136:139], v[128:131], v[64:67]
    ds_read_b64_tr_b16 v[102:103], v155 offset:256
    v_mfma_f32_16x16x32_bf16 v[8:11], v[140:143], v[116:119], v[8:11]
    ds_read_b64_tr_b16 v[104:105], v154 offset:1024
    v_mfma_f32_16x16x32_bf16 v[28:31], v[140:143], v[120:123], v[28:31]
    ds_read_b64_tr_b16 v[106:107], v154 offset:1280
    v_mfma_f32_16x16x32_bf16 v[48:51], v[140:143], v[124:127], v[48:51]
    ds_read_b64_tr_b16 v[108:109], v155 offset:1024
    v_mfma_f32_16x16x32_bf16 v[68:71], v[140:143], v[128:131], v[68:71]
    ds_read_b64_tr_b16 v[110:111], v155 offset:1280
    v_mfma_f32_16x16x32_bf16 v[12:15], v[144:147], v[116:119], v[12:15]
    ds_read_b64_tr_b16 v[112:113], v154 offset:2048
    v_mfma_f32_16x16x32_bf16 v[32:35], v[144:147], v[120:123], v[32:35]
    ds_read_b64_tr_b16 v[114:115], v154 offset:2304
    v_mfma_f32_16x16x32_bf16 v[52:55], v[144:147], v[124:127], v[52:55]
    v_mfma_f32_16x16x32_bf16 v[72:75], v[144:147], v[128:131], v[72:75]
    v_mfma_f32_16x16x32_bf16 v[16:19], v[148:151], v[116:119], v[16:19]
    v_mfma_f32_16x16x32_bf16 v[36:39], v[148:151], v[120:123], v[36:39]
    v_mfma_f32_16x16x32_bf16 v[56:59], v[148:151], v[124:127], v[56:59]
    v_mfma_f32_16x16x32_bf16 v[76:79], v[148:151], v[128:131], v[76:79]
    v_mfma_f32_16x16x32_bf16 v[232:235], v[228:231], v[116:119], v[232:235]
    v_mfma_f32_16x16x32_bf16 v[180:183], v[116:119], v[116:119], v[180:183]
    v_mfma_f32_16x16x32_bf16 v[236:239], v[228:231], v[120:123], v[236:239]
    v_mfma_f32_16x16x32_bf16 v[184:187], v[120:123], v[120:123], v[184:187]
    v_mfma_f32_16x16x32_bf16 v[240:243], v[228:231], v[124:127], v[240:243]
    v_mfma_f32_16x16x32_bf16 v[188:191], v[124:127], v[124:127], v[188:191]
    v_mfma_f32_16x16x32_bf16 v[244:247], v[228:231], v[128:131], v[244:247]
    v_mfma_f32_16x16x32_bf16 v[192:195], v[128:131], v[128:131], v[192:195]
    s_waitcnt lgkmcnt(0)
    s_cbranch_scc0 L_k1_main_h1
    s_barrier
    s_branch L_k1_qh_epi
L_k1_q_main:
    s_mov_b32 s40, 0
    s_mov_b32 s51, 0
    s_barrier
    ds_read_b64_tr_b16 v[96:97], v154 offset:0
    ds_read_b64_tr_b16 v[98:99], v154 offset:256
    ds_read_b128 v[80:83], v152 offset:0
    ds_read_b128 v[84:87], v152 offset:2048
    ds_read_b128 v[88:91], v152 offset:4096
    ds_read_b128 v[92:95], v152 offset:6144
    ds_read_b64_tr_b16 v[100:101], v155 offset:0
    ds_read_b64_tr_b16 v[102:103], v155 offset:256
    ds_read_b64_tr_b16 v[104:105], v154 offset:1024
    ds_read_b64_tr_b16 v[106:107], v154 offset:1280
    ds_read_b64_tr_b16 v[108:109], v155 offset:1024
    ds_read_b64_tr_b16 v[110:111], v155 offset:1280
    ds_read_b64_tr_b16 v[112:113], v154 offset:2048
    ds_read_b64_tr_b16 v[114:115], v154 offset:2304
    s_waitcnt lgkmcnt(0)
L_k1_main_sw:
    v_mfma_f32_16x16x32_bf16 v[0:3], v[96:99], v[80:83], v[0:3]
    ds_read_b64_tr_b16 v[132:133], v154 offset:10240
    v_mfma_f32_16x16x32_bf16 v[20:23], v[96:99], v[84:87], v[20:23]
    ds_read_b64_tr_b16 v[134:135], v154 offset:10496
    v_mfma_f32_16x16x32_bf16 v[40:43], v[96:99], v[88:91], v[40:43]
    ds_read_b128 v[116:119], v153 offset:0
    v_mfma_f32_16x16x32_bf16 v[60:63], v[96:99], v[92:95], v[60:63]
    ds_read_b128 v[120:123], v153 offset:2048
    v_mfma_f32_16x16x32_bf16 v[4:7], v[100:103], v[80:83], v[4:7]
    ds_read_b128 v[124:127], v153 offset:4096
    v_mfma_f32_16x16x32_bf16 v[24:27], v[100:103], v[84:87], v[24:27]
    ds_read_b128 v[128:131], v153 offset:6144
    v_mfma_f32_16x16x32_bf16 v[44:47], v[100:103], v[88:91], v[44:47]
    ds_read_b64_tr_b16 v[136:137], v155 offset:10240
    v_mfma_f32_16x16x32_bf16 v[64:67], v[100:103], v[92:95], v[64:67]
    ds_read_b64_tr_b16 v[138:139], v155 offset:10496
    v_mfma_f32_16x16x32_bf16 v[8:11], v[104:107], v[80:83], v[8:11]
    ds_read_b64_tr_b16 v[140:141], v154 offset:11264
    v_mfma_f32_16x16x32_bf16 v[28:31], v[104:107], v[84:87], v[28:31]
    ds_read_b64_tr_b16 v[142:143], v154 offset:11520
    v_mfma_f32_16x16x32_bf16 v[48:51], v[104:107], v[88:91], v[48:51]
    ds_read_b64_tr_b16 v[144:145], v155 offset:11264
    v_mfma_f32_16x16x32_bf16 v[68:71], v[104:107], v[92:95], v[68:71]
    ds_read_b64_tr_b16 v[146:147], v155 offset:11520
    v_mfma_f32_16x16x32_bf16 v[12:15], v[108:111], v[80:83], v[12:15]
    ds_read_b64_tr_b16 v[148:149], v154 offset:12288
    v_mfma_f32_16x16x32_bf16 v[32:35], v[108:111], v[84:87], v[32:35]
    ds_read_b64_tr_b16 v[150:151], v154 offset:12544
    s_add_u32 s40, s40, 1
    s_and_b32 s41, s40, 3
    v_mfma_f32_16x16x32_bf16 v[52:55], v[108:111], v[88:91], v[52:55]
    s_add_u32 s51, s51, 1
    s_movk_i32 s42, 16384
    v_mfma_f32_16x16x32_bf16 v[72:75], v[108:111], v[92:95], v[72:75]
    s_movk_i32 s43, 20480
    s_cmp_eq_u32 s41, 0
    v_mfma_f32_16x16x32_bf16 v[16:19], v[112:115], v[80:83], v[16:19]
    s_cselect_b32 s43, 0xffff1000, s43
    s_cmp_eq_u32 s51, 3
    v_mfma_f32_16x16x32_bf16 v[36:39], v[112:115], v[84:87], v[36:39]
    s_cselect_b32 s42, 0xffff8000, s42
    s_cselect_b32 s51, 0, s51
    v_mfma_f32_16x16x32_bf16 v[56:59], v[112:115], v[88:91], v[56:59]
    v_add_u32 v152, s42, v152
    v_add_u32 v153, s42, v153
    v_mfma_f32_16x16x32_bf16 v[76:79], v[112:115], v[92:95], v[76:79]
    v_add_u32 v154, s43, v154
    v_add_u32 v155, s43, v155
    s_cmp_eq_u32 s40, 10
    s_waitcnt lgkmcnt(0)
    s_cbranch_scc1 L_k1_nobar_sw
    s_barrier
L_k1_nobar_sw:
    v_mfma_f32_16x16x32_bf16 v[0:3], v[132:135], v[116:119], v[0:3]
    ds_read_b64_tr_b16 v[96:97], v154 offset:0
    v_mfma_f32_16x16x32_bf16 v[20:23], v[132:135], v[120:123], v[20:23]
    ds_read_b64_tr_b16 v[98:99], v154 offset:256
    v_mfma_f32_16x16x32_bf16 v[40:43], v[132:135], v[124:127], v[40:43]
    ds_read_b128 v[80:83], v152 offset:0
    v_mfma_f32_16x16x32_bf16 v[60:63], v[132:135], v[128:131], v[60:63]
    ds_read_b128 v[84:87], v152 offset:2048
    v_mfma_f32_16x16x32_bf16 v[4:7], v[136:139], v[116:119], v[4:7]
    ds_read_b128 v[88:91], v152 offset:4096
    v_mfma_f32_16x16x32_bf16 v[24:27], v[136:139], v[120:123], v[24:27]
    ds_read_b128 v[92:95], v152 offset:6144
    v_mfma_f32_16x16x32_bf16 v[44:47], v[136:139], v[124:127], v[44:47]
    ds_read_b64_tr_b16 v[100:101], v155 offset:0
    v_mfma_f32_16x16x32_bf16 v[64:67], v[136:139], v[128:131], v[64:67]
    ds_read_b64_tr_b16 v[102:103], v155 offset:256
    v_mfma_f32_16x16x32_bf16 v[8:11], v[140:143], v[116:119], v[8:11]
    ds_read_b64_tr_b16 v[104:105], v154 offset:1024
    v_mfma_f32_16x16x32_bf16 v[28:31], v[140:143], v[120:123], v[28:31]
    ds_read_b64_tr_b16 v[106:107], v154 offset:1280
    v_mfma_f32_16x16x32_bf16 v[48:51], v[140:143], v[124:127], v[48:51]
    ds_read_b64_tr_b16 v[108:109], v155 offset:1024
    v_mfma_f32_16x16x32_bf16 v[68:71], v[140:143], v[128:131], v[68:71]
    ds_read_b64_tr_b16 v[110:111], v155 offset:1280
    v_mfma_f32_16x16x32_bf16 v[12:15], v[144:147], v[116:119], v[12:15]
    ds_read_b64_tr_b16 v[112:113], v154 offset:2048
    v_mfma_f32_16x16x32_bf16 v[32:35], v[144:147], v[120:123], v[32:35]
    ds_read_b64_tr_b16 v[114:115], v154 offset:2304
    v_mfma_f32_16x16x32_bf16 v[52:55], v[144:147], v[124:127], v[52:55]
    v_mfma_f32_16x16x32_bf16 v[72:75], v[144:147], v[128:131], v[72:75]
    v_mfma_f32_16x16x32_bf16 v[16:19], v[148:151], v[116:119], v[16:19]
    v_mfma_f32_16x16x32_bf16 v[36:39], v[148:151], v[120:123], v[36:39]
    v_mfma_f32_16x16x32_bf16 v[56:59], v[148:151], v[124:127], v[56:59]
    v_mfma_f32_16x16x32_bf16 v[76:79], v[148:151], v[128:131], v[76:79]
    s_waitcnt lgkmcnt(0)
    s_cbranch_scc0 L_k1_main_sw
    s_barrier
L_k1_qh_epi:
    s_cmp_eq_u32 s18, 3
    s_cbranch_scc1 L_k1_epi_h
L_k1_q_loop:
    s_set_gpr_idx_on s46, 0x1
    s_nop 0
    v_mul_f32 v80, v0, v158
    v_max_f32 v100, v0, v159
    v_mul_f32 v81, v1, v158
    v_max_f32 v101, v1, v159
    v_mul_f32 v82, v2, v158
    v_max_f32 v102, v2, v159
    v_mul_f32 v83, v3, v158
    v_max_f32 v103, v3, v159
    v_mul_f32 v84, v4, v158
    v_max_f32 v104, v4, v159
    v_mul_f32 v85, v5, v158
    v_max_f32 v105, v5, v159
    v_mul_f32 v86, v6, v158
    v_max_f32 v106, v6, v159
    v_mul_f32 v87, v7, v158
    v_max_f32 v107, v7, v159
    v_mul_f32 v88, v8, v158
    v_max_f32 v108, v8, v159
    v_mul_f32 v89, v9, v158
    v_max_f32 v109, v9, v159
    v_mul_f32 v90, v10, v158
    v_max_f32 v110, v10, v159
    v_mul_f32 v91, v11, v158
    v_max_f32 v111, v11, v159
    v_mul_f32 v92, v12, v158
    v_max_f32 v112, v12, v159
    v_mul_f32 v93, v13, v158
    v_max_f32 v113, v13, v159
    v_mul_f32 v94, v14, v158
    v_max_f32 v114, v14, v159
    v_mul_f32 v95, v15, v158
    v_max_f32 v115, v15, v159
    v_mul_f32 v96, v16, v158
    v_max_f32 v116, v16, v159
    v_mul_f32 v97, v17, v158
    v_max_f32 v117, v17, v159
    v_mul_f32 v98, v18, v158
    v_max_f32 v118, v18, v159
    v_mul_f32 v99, v19, v158
    v_max_f32 v119, v19, v159
    s_set_gpr_idx_off
    v_exp_f32_e64 v80, v80 clamp
    v_exp_f32_e64 v81, v81 clamp
    v_exp_f32_e64 v82, v82 clamp
    v_exp_f32_e64 v83, v83 clamp
    v_exp_f32_e64 v84, v84 clamp
    v_exp_f32_e64 v85, v85 clamp
    v_exp_f32_e64 v86, v86 clamp
    v_exp_f32_e64 v87, v87 clamp
    v_exp_f32_e64 v88, v88 clamp
    v_exp_f32_e64 v89, v89 clamp
    v_exp_f32_e64 v90, v90 clamp
    v_exp_f32_e64 v91, v91 clamp
    v_exp_f32_e64 v92, v92 clamp
    v_exp_f32_e64 v93, v93 clamp
    v_exp_f32_e64 v94, v94 clamp
    v_exp_f32_e64 v95, v95 clamp
    v_exp_f32_e64 v96, v96 clamp
    v_exp_f32_e64 v97, v97 clamp
    v_exp_f32_e64 v98, v98 clamp
    v_exp_f32_e64 v99, v99 clamp
    v_pk_add_f32 v[80:81], v[80:81], s[44:45] op_sel_hi:[1,0]
    v_pk_add_f32 v[82:83], v[82:83], s[44:45] op_sel_hi:[1,0]
    v_pk_add_f32 v[84:85], v[84:85], s[44:45] op_sel_hi:[1,0]
    v_pk_add_f32 v[86:87], v[86:87], s[44:45] op_sel_hi:[1,0]
    v_pk_add_f32 v[88:89], v[88:89], s[44:45] op_sel_hi:[1,0]
    v_pk_add_f32 v[90:91], v[90:91], s[44:45] op_sel_hi:[1,0]
    v_pk_add_f32 v[92:93], v[92:93], s[44:45] op_sel_hi:[1,0]
    v_pk_add_f32 v[94:95], v[94:95], s[44:45] op_sel_hi:[1,0]
    v_pk_add_f32 v[96:97], v[96:97], s[44:45] op_sel_hi:[1,0]
    v_pk_add_f32 v[98:99], v[98:99], s[44:45] op_sel_hi:[1,0]
    v_pk_add_f32 v[100:101], v[100:101], v[80:81]
    v_pk_add_f32 v[102:103], v[102:103], v[82:83]
    v_pk_add_f32 v[104:105], v[104:105], v[84:85]
    v_pk_add_f32 v[106:107], v[106:107], v[86:87]
    v_pk_add_f32 v[108:109], v[108:109], v[88:89]
    v_pk_add_f32 v[110:111], v[110:111], v[90:91]
    v_pk_add_f32 v[112:113], v[112:113], v[92:93]
    v_pk_add_f32 v[114:115], v[114:115], v[94:95]
    v_pk_add_f32 v[116:117], v[116:117], v[96:97]
    v_pk_add_f32 v[118:119], v[118:119], v[98:99]
    v_cvt_pk_bf16_f32 v120, v100, v101
    v_cvt_pk_bf16_f32 v121, v102, v103
    v_cvt_pk_bf16_f32 v122, v104, v105
    v_cvt_pk_bf16_f32 v123, v106, v107
    v_cvt_pk_bf16_f32 v124, v108, v109
    v_cvt_pk_bf16_f32 v125, v110, v111
    v_cvt_pk_bf16_f32 v126, v112, v113
    v_cvt_pk_bf16_f32 v127, v114, v115
    v_cvt_pk_bf16_f32 v128, v116, v117
    v_cvt_pk_bf16_f32 v129, v118, v119
    v_permlane16_swap_b32 v120, v122
    v_permlane16_swap_b32 v121, v123
    v_permlane16_swap_b32 v124, v126
    v_permlane16_swap_b32 v125, v127
    buffer_store_dwordx2 v[128:129], v157, s[32:35], s47 offen sc1
    buffer_store_dwordx4 v[120:123], v156, s[32:35], s47 offen sc1
    s_add_u32 s48, s47, s60
    buffer_store_dwordx4 v[124:127], v156, s[32:35], s48 offen sc1
    s_add_u32 s46, s46, 20
    s_add_u32 s47, s47, 256
    s_cmp_lt_u32 s46, 80
    s_cbranch_scc1 L_k1_q_loop
    s_waitcnt vmcnt(0)
    s_add_u32 s98, s98, 1
    s_lshl_b32 s99, s22, 2
    s_add_u32 s99, s99, 163712
    v_mov_b32 v164, s99
    v_mov_b32 v165, s98
    s_waitcnt lgkmcnt(0)
    ds_write_b32 v164, v165
    v_mov_b32 v164, 163712
L_csync_7:
    ds_read_b128 v[160:163], v164
    s_waitcnt lgkmcnt(0)
    v_min_u32 v160, v160, v161
    v_min_u32 v162, v162, v163
    v_min_u32 v160, v160, v162
    v_cmp_le_u32 vcc, v165, v160
    s_nop 0
    s_cbranch_vccz L_csync_7
    s_cmp_eq_u32 s22, 0
    s_cbranch_scc0 L_dc_6
    s_mov_b32 s92, s96
    s_mov_b32 s93, s97
    s_mov_b32 s94, 256
    s_mov_b32 s95, 0x20000
    s_and_b32 s99, s2, 1
    s_lshl_b32 s99, s99, 7
    v_mov_b32 v160, s99
    v_mov_b32 v161, 1
    s_mov_b64 exec, 1
    buffer_atomic_add v161, v160, s[92:95], 0 offen sc0 sc1
    s_waitcnt vmcnt(0)
    v_readfirstlane_b32 s99, v161
    s_mov_b64 exec, -1
    s_and_b32 s99, s99, 127
    s_cmp_eq_u32 s99, 127
    s_cbranch_scc0 L_arr_8
    s_add_u32 s92, s12, 23379968
    s_addc_u32 s93, s13, 0
    s_mov_b32 s94, 40960
    s_mov_b32 s95, 0x20000
    s_and_b32 s99, s2, 1
    s_lshl_b32 s99, s99, 2
    s_add_u32 s99, s99, 8192
    v_and_b32 v160, 63, v254
    v_lshlrev_b32 v160, 7, v160
    v_add_u32 v160, s99, v160
    v_mov_b32 v161, 1
    buffer_store_dword v161, v160, s[92:95], 0 offen sc1
    v_add_u32 v160, 0x2000, v160
    buffer_store_dword v161, v160, s[92:95], 0 offen sc1
    v_add_u32 v160, 0x2000, v160
    buffer_store_dword v161, v160, s[92:95], 0 offen sc1
    v_add_u32 v160, 0x2000, v160
    buffer_store_dword v161, v160, s[92:95], 0 offen sc1
L_arr_8:
    v_mov_b32 v160, 163732
    v_mov_b32 v161, 1
    ds_write_b32 v160, v161
L_dc_6:
    s_branch L_phase2
L_k1_epi_h:
    v_cndmask_b32 v204, v180, v181, s[52:53]
    v_cndmask_b32 v205, v184, v185, s[52:53]
    v_cndmask_b32 v206, v188, v189, s[52:53]
    v_cndmask_b32 v207, v192, v193, s[52:53]
    v_cndmask_b32 v204, v204, v182, s[54:55]
    v_cndmask_b32 v205, v205, v186, s[54:55]
    v_cndmask_b32 v206, v206, v190, s[54:55]
    v_cndmask_b32 v207, v207, v194, s[54:55]
    v_cndmask_b32 v204, v204, v183, s[56:57]
    v_cndmask_b32 v205, v205, v187, s[56:57]
    v_cndmask_b32 v206, v206, v191, s[56:57]
    v_cndmask_b32 v207, v207, v195, s[56:57]
    v_cndmask_b32 v204, 0, v204, s[58:59]
    v_cndmask_b32 v205, 0, v205, s[58:59]
    v_cndmask_b32 v206, 0, v206, s[58:59]
    v_cndmask_b32 v207, 0, v207, s[58:59]
    v_mov_b32 v200, v232
    v_mov_b32 v201, v236
    v_mov_b32 v202, v240
    v_mov_b32 v203, v244
    v_mov_b32 v80, v204
    v_mov_b32 v81, v205
    v_mov_b32 v82, v206
    v_mov_b32 v83, v207
    s_nop 1
    v_permlane16_swap_b32 v80, v204
    v_permlane16_swap_b32 v81, v205
    v_permlane16_swap_b32 v82, v206
    v_permlane16_swap_b32 v83, v207
    s_nop 1
    v_add_f32 v204, v204, v80
    v_add_f32 v205, v205, v81
    v_add_f32 v206, v206, v82
    v_add_f32 v207, v207, v83
    s_nop 0
    v_mov_b32 v80, v204
    v_mov_b32 v81, v205
    v_mov_b32 v82, v206
    v_mov_b32 v83, v207
    s_nop 1
    v_permlane32_swap_b32 v80, v204
    v_permlane32_swap_b32 v81, v205
    v_permlane32_swap_b32 v82, v206
    v_permlane32_swap_b32 v83, v207
    s_nop 1
    v_add_f32 v204, v204, v80
    v_add_f32 v205, v205, v81
    v_add_f32 v206, v206, v82
    v_add_f32 v207, v207, v83
    s_nop 0
    v_mov_b32 v80, v200
    v_mov_b32 v81, v204
    ds_write_b64 v172, v[80:81] offset:0
    v_mov_b32 v82, v201
    v_mov_b32 v83, v205
    ds_write_b64 v172, v[82:83] offset:128
    v_mov_b32 v84, v202
    v_mov_b32 v85, v206
    ds_write_b64 v172, v[84:85] offset:256
    v_mov_b32 v86, v203
    v_mov_b32 v87, v207
    ds_write_b64 v172, v[86:87] offset:384
    ds_write_b128 v173, v[208:211] offset:4096
    ds_write_b128 v173, v[212:215] offset:4160
    ds_write_b128 v173, v[216:219] offset:4224
    ds_write_b128 v173, v[220:223] offset:4288
    ds_write_b128 v173, v[224:227] offset:4352
    s_waitcnt lgkmcnt(0)
    s_add_u32 s98, s98, 1
    s_lshl_b32 s99, s22, 2
    s_add_u32 s99, s99, 163712
    v_mov_b32 v124, s99
    v_mov_b32 v125, s98
    s_waitcnt lgkmcnt(0)
    ds_write_b32 v124, v125
    v_mov_b32 v124, 163712
L_csync_9:
    ds_read_b128 v[120:123], v124
    s_waitcnt lgkmcnt(0)
    v_min_u32 v120, v120, v121
    v_min_u32 v122, v122, v123
    v_min_u32 v120, v120, v122
    v_cmp_le_u32 vcc, v125, v120
    s_nop 0
    s_cbranch_vccz L_csync_9
    ds_read_b64 v[80:81], v174 offset:0
    ds_read_b64 v[82:83], v174 offset:128
    ds_read_b64 v[84:85], v174 offset:256
    ds_read_b64 v[86:87], v174 offset:384
    ds_read_b128 v[100:103], v175 offset:4096
    ds_read_b128 v[104:107], v175 offset:4160
    ds_read_b128 v[108:111], v175 offset:4224
    ds_read_b128 v[112:115], v175 offset:4288
    ds_read_b128 v[116:119], v175 offset:4352
    s_waitcnt lgkmcnt(5)
    v_add_f32 v200, v200, v80
    v_add_f32 v204, v204, v81
    v_add_f32 v201, v201, v82
    v_add_f32 v205, v205, v83
    v_add_f32 v202, v202, v84
    v_add_f32 v206, v206, v85
    v_add_f32 v203, v203, v86
    v_add_f32 v207, v207, v87
    s_mov_b32 s44, 0xbacccccd
    s_mov_b32 s45, 0x3acccccd
    v_mul_f32 v132, s44, v200
    v_mul_f32 v136, s44, v201
    v_mul_f32 v140, s44, v202
    v_mul_f32 v144, s44, v203
    v_mul_f32 v133, s45, v204
    v_mul_f32 v137, s45, v205
    v_mul_f32 v141, s45, v206
    v_mul_f32 v145, s45, v207
    s_mov_b32 s44, 0x3727c5ac
    v_fma_f32 v133, -v132, v132, v133
    v_fma_f32 v137, -v136, v136, v137
    v_fma_f32 v141, -v140, v140, v141
    v_fma_f32 v145, -v144, v144, v145
    v_max_f32 v133, 0, v133
    v_max_f32 v137, 0, v137
    v_max_f32 v141, 0, v141
    v_max_f32 v145, 0, v145
    v_add_f32 v133, s44, v133
    v_add_f32 v137, s44, v137
    v_add_f32 v141, s44, v141
    v_add_f32 v145, s44, v145
    v_rsq_f32 v134, v133
    v_rsq_f32 v138, v137
    v_rsq_f32 v142, v141
    v_rsq_f32 v146, v145
    v_sqrt_f32 v133, v133
    v_sqrt_f32 v137, v137
    v_sqrt_f32 v141, v141
    v_sqrt_f32 v145, v145
    s_mov_b32 s44, 0xbdd2d3e8
    s_mov_b32 s45, 0xc0135761
    v_mul_f32 v135, v134, v134
    v_mul_f32 v139, v138, v138
    v_mul_f32 v143, v142, v142
    v_mul_f32 v147, v146, v146
    v_mul_f32 v135, v135, v134
    v_mul_f32 v139, v139, v138
    v_mul_f32 v143, v143, v142
    v_mul_f32 v147, v147, v146
    v_mul_f32 v135, s44, v135
    v_mul_f32 v139, s44, v139
    v_mul_f32 v143, s44, v143
    v_mul_f32 v147, s44, v147
    v_mul_f32 v134, s45, v134
    v_mul_f32 v138, s45, v138
    v_mul_f32 v142, s45, v142
    v_mul_f32 v146, s45, v146
    s_waitcnt lgkmcnt(0)
    v_add_f32 v208, v208, v100
    v_add_f32 v209, v209, v101
    v_add_f32 v210, v210, v102
    v_add_f32 v211, v211, v103
    v_add_f32 v212, v212, v104
    v_add_f32 v213, v213, v105
    v_add_f32 v214, v214, v106
    v_add_f32 v215, v215, v107
    v_add_f32 v216, v216, v108
    v_add_f32 v217, v217, v109
    v_add_f32 v218, v218, v110
    v_add_f32 v219, v219, v111
    v_add_f32 v220, v220, v112
    v_add_f32 v221, v221, v113
    v_add_f32 v222, v222, v114
    v_add_f32 v223, v223, v115
    v_add_f32 v224, v224, v116
    v_add_f32 v225, v225, v117
    v_add_f32 v226, v226, v118
    v_add_f32 v227, v227, v119
    s_mov_b32 s49, 0
L_k1_h_loop:
    s_set_gpr_idx_on s49, 0x1
    s_nop 0
    v_mov_b32 v148, v132
    v_mov_b32 v149, v133
    v_mov_b32 v150, v134
    v_mov_b32 v151, v135
    s_set_gpr_idx_off
    s_add_u32 s49, s49, 4
    s_set_gpr_idx_on s46, 0x4
    s_nop 0
    v_fma_f32 v80, v208, v148, v0
    v_fma_f32 v81, v209, v148, v1
    v_fma_f32 v82, v210, v148, v2
    v_fma_f32 v83, v211, v148, v3
    v_fma_f32 v84, v212, v148, v4
    v_fma_f32 v85, v213, v148, v5
    v_fma_f32 v86, v214, v148, v6
    v_fma_f32 v87, v215, v148, v7
    v_fma_f32 v88, v216, v148, v8
    v_fma_f32 v89, v217, v148, v9
    v_fma_f32 v90, v218, v148, v10
    v_fma_f32 v91, v219, v148, v11
    v_fma_f32 v92, v220, v148, v12
    v_fma_f32 v93, v221, v148, v13
    v_fma_f32 v94, v222, v148, v14
    v_fma_f32 v95, v223, v148, v15
    v_fma_f32 v96, v224, v148, v16
    v_fma_f32 v97, v225, v148, v17
    v_fma_f32 v98, v226, v148, v18
    v_fma_f32 v99, v227, v148, v19
    s_set_gpr_idx_off
    v_pk_mul_f32 v[100:101], v[80:81], v[80:81]
    v_pk_mul_f32 v[102:103], v[82:83], v[82:83]
    v_pk_mul_f32 v[104:105], v[84:85], v[84:85]
    v_pk_mul_f32 v[106:107], v[86:87], v[86:87]
    v_pk_mul_f32 v[108:109], v[88:89], v[88:89]
    v_pk_mul_f32 v[110:111], v[90:91], v[90:91]
    v_pk_mul_f32 v[112:113], v[92:93], v[92:93]
    v_pk_mul_f32 v[114:115], v[94:95], v[94:95]
    v_pk_mul_f32 v[116:117], v[96:97], v[96:97]
    v_pk_mul_f32 v[118:119], v[98:99], v[98:99]
    v_pk_fma_f32 v[100:101], v[100:101], v[150:151], v[150:151] op_sel:[0,1,0] op_sel_hi:[1,1,0]
    v_pk_fma_f32 v[102:103], v[102:103], v[150:151], v[150:151] op_sel:[0,1,0] op_sel_hi:[1,1,0]
    v_pk_fma_f32 v[104:105], v[104:105], v[150:151], v[150:151] op_sel:[0,1,0] op_sel_hi:[1,1,0]
    v_pk_fma_f32 v[106:107], v[106:107], v[150:151], v[150:151] op_sel:[0,1,0] op_sel_hi:[1,1,0]
    v_pk_fma_f32 v[108:109], v[108:109], v[150:151], v[150:151] op_sel:[0,1,0] op_sel_hi:[1,1,0]
    v_pk_fma_f32 v[110:111], v[110:111], v[150:151], v[150:151] op_sel:[0,1,0] op_sel_hi:[1,1,0]
    v_pk_fma_f32 v[112:113], v[112:113], v[150:151], v[150:151] op_sel:[0,1,0] op_sel_hi:[1,1,0]
    v_pk_fma_f32 v[114:115], v[114:115], v[150:151], v[150:151] op_sel:[0,1,0] op_sel_hi:[1,1,0]
    v_pk_fma_f32 v[116:117], v[116:117], v[150:151], v[150:151] op_sel:[0,1,0] op_sel_hi:[1,1,0]
    v_pk_fma_f32 v[118:119], v[118:119], v[150:151], v[150:151] op_sel:[0,1,0] op_sel_hi:[1,1,0]
    v_pk_mul_f32 v[100:101], v[100:101], v[80:81]
    v_pk_mul_f32 v[102:103], v[102:103], v[82:83]
    v_pk_mul_f32 v[104:105], v[104:105], v[84:85]
    v_pk_mul_f32 v[106:107], v[106:107], v[86:87]
    v_pk_mul_f32 v[108:109], v[108:109], v[88:89]
    v_pk_mul_f32 v[110:111], v[110:111], v[90:91]
    v_pk_mul_f32 v[112:113], v[112:113], v[92:93]
    v_pk_mul_f32 v[114:115], v[114:115], v[94:95]
    v_pk_mul_f32 v[116:117], v[116:117], v[96:97]
    v_pk_mul_f32 v[118:119], v[118:119], v[98:99]
    v_exp_f32 v100, v100
    v_exp_f32 v101, v101
    v_exp_f32 v102, v102
    v_exp_f32 v103, v103
    v_exp_f32 v104, v104
    v_exp_f32 v105, v105
    v_exp_f32 v106, v106
    v_exp_f32 v107, v107
    v_exp_f32 v108, v108
    v_exp_f32 v109, v109
    v_exp_f32 v110, v110
    v_exp_f32 v111, v111
    v_exp_f32 v112, v112
    v_exp_f32 v113, v113
    v_exp_f32 v114, v114
    v_exp_f32 v115, v115
    v_exp_f32 v116, v116
    v_exp_f32 v117, v117
    v_exp_f32 v118, v118
    v_exp_f32 v119, v119
    v_pk_fma_f32 v[100:101], v[100:101], v[148:149], v[148:149] op_sel:[0,1,1] op_sel_hi:[1,1,1]
    v_pk_fma_f32 v[102:103], v[102:103], v[148:149], v[148:149] op_sel:[0,1,1] op_sel_hi:[1,1,1]
    v_pk_fma_f32 v[104:105], v[104:105], v[148:149], v[148:149] op_sel:[0,1,1] op_sel_hi:[1,1,1]
    v_pk_fma_f32 v[106:107], v[106:107], v[148:149], v[148:149] op_sel:[0,1,1] op_sel_hi:[1,1,1]
    v_pk_fma_f32 v[108:109], v[108:109], v[148:149], v[148:149] op_sel:[0,1,1] op_sel_hi:[1,1,1]
    v_pk_fma_f32 v[110:111], v[110:111], v[148:149], v[148:149] op_sel:[0,1,1] op_sel_hi:[1,1,1]
    v_pk_fma_f32 v[112:113], v[112:113], v[148:149], v[148:149] op_sel:[0,1,1] op_sel_hi:[1,1,1]
    v_pk_fma_f32 v[114:115], v[114:115], v[148:149], v[148:149] op_sel:[0,1,1] op_sel_hi:[1,1,1]
    v_pk_fma_f32 v[116:117], v[116:117], v[148:149], v[148:149] op_sel:[0,1,1] op_sel_hi:[1,1,1]
    v_pk_fma_f32 v[118:119], v[118:119], v[148:149], v[148:149] op_sel:[0,1,1] op_sel_hi:[1,1,1]
    v_rcp_f32 v100, v100
    v_rcp_f32 v101, v101
    v_rcp_f32 v102, v102
    v_rcp_f32 v103, v103
    v_rcp_f32 v104, v104
    v_rcp_f32 v105, v105
    v_rcp_f32 v106, v106
    v_rcp_f32 v107, v107
    v_rcp_f32 v108, v108
    v_rcp_f32 v109, v109
    v_rcp_f32 v110, v110
    v_rcp_f32 v111, v111
    v_rcp_f32 v112, v112
    v_rcp_f32 v113, v113
    v_rcp_f32 v114, v114
    v_rcp_f32 v115, v115
    v_rcp_f32 v116, v116
    v_rcp_f32 v117, v117
    v_rcp_f32 v118, v118
    v_rcp_f32 v119, v119
    v_pk_mul_f32 v[80:81], v[80:81], v[100:101]
    v_pk_mul_f32 v[82:83], v[82:83], v[102:103]
    v_pk_mul_f32 v[84:85], v[84:85], v[104:105]
    v_pk_mul_f32 v[86:87], v[86:87], v[106:107]
    v_pk_mul_f32 v[88:89], v[88:89], v[108:109]
    v_pk_mul_f32 v[90:91], v[90:91], v[110:111]
    v_pk_mul_f32 v[92:93], v[92:93], v[112:113]
    v_pk_mul_f32 v[94:95], v[94:95], v[114:115]
    v_pk_mul_f32 v[96:97], v[96:97], v[116:117]
    v_pk_mul_f32 v[98:99], v[98:99], v[118:119]
    v_cvt_pk_bf16_f32 v120, v80, v81
    v_cvt_pk_bf16_f32 v121, v82, v83
    v_cvt_pk_bf16_f32 v122, v84, v85
    v_cvt_pk_bf16_f32 v123, v86, v87
    v_cvt_pk_bf16_f32 v124, v88, v89
    v_cvt_pk_bf16_f32 v125, v90, v91
    v_cvt_pk_bf16_f32 v126, v92, v93
    v_cvt_pk_bf16_f32 v127, v94, v95
    v_cvt_pk_bf16_f32 v128, v96, v97
    v_cvt_pk_bf16_f32 v129, v98, v99
    v_permlane16_swap_b32 v120, v122
    v_permlane16_swap_b32 v121, v123
    v_permlane16_swap_b32 v124, v126
    v_permlane16_swap_b32 v125, v127
    buffer_store_dwordx2 v[128:129], v157, s[32:35], s47 offen sc1
    buffer_store_dwordx4 v[120:123], v156, s[32:35], s47 offen sc1
    s_add_u32 s48, s47, s60
    buffer_store_dwordx4 v[124:127], v156, s[32:35], s48 offen sc1
    s_add_u32 s46, s46, 20
    s_add_u32 s47, s47, 256
    s_cmp_lt_u32 s46, 80
    s_cbranch_scc1 L_k1_h_loop
    s_waitcnt vmcnt(0)
    s_add_u32 s98, s98, 1
    s_lshl_b32 s99, s22, 2
    s_add_u32 s99, s99, 163712
    v_mov_b32 v164, s99
    v_mov_b32 v165, s98
    s_waitcnt lgkmcnt(0)
    ds_write_b32 v164, v165
    v_mov_b32 v164, 163712
L_csync_11:
    ds_read_b128 v[160:163], v164
    s_waitcnt lgkmcnt(0)
    v_min_u32 v160, v160, v161
    v_min_u32 v162, v162, v163
    v_min_u32 v160, v160, v162
    v_cmp_le_u32 vcc, v165, v160
    s_nop 0
    s_cbranch_vccz L_csync_11
    s_cmp_eq_u32 s22, 0
    s_cbranch_scc0 L_dc_10
    s_mov_b32 s92, s96
    s_mov_b32 s93, s97
    s_mov_b32 s94, 256
    s_mov_b32 s95, 0x20000
    s_and_b32 s99, s2, 1
    s_lshl_b32 s99, s99, 7
    v_mov_b32 v160, s99
    v_mov_b32 v161, 1
    s_mov_b64 exec, 1
    buffer_atomic_add v161, v160, s[92:95], 0 offen sc0 sc1
    s_waitcnt vmcnt(0)
    v_readfirstlane_b32 s99, v161
    s_mov_b64 exec, -1
    s_and_b32 s99, s99, 127
    s_cmp_eq_u32 s99, 127
    s_cbranch_scc0 L_arr_12
    s_add_u32 s92, s12, 23379968
    s_addc_u32 s93, s13, 0
    s_mov_b32 s94, 40960
    s_mov_b32 s95, 0x20000
    s_and_b32 s99, s2, 1
    s_lshl_b32 s99, s99, 2
    s_add_u32 s99, s99, 8192
    v_and_b32 v160, 63, v254
    v_lshlrev_b32 v160, 7, v160
    v_add_u32 v160, s99, v160
    v_mov_b32 v161, 1
    buffer_store_dword v161, v160, s[92:95], 0 offen sc1
    v_add_u32 v160, 0x2000, v160
    buffer_store_dword v161, v160, s[92:95], 0 offen sc1
    v_add_u32 v160, 0x2000, v160
    buffer_store_dword v161, v160, s[92:95], 0 offen sc1
    v_add_u32 v160, 0x2000, v160
    buffer_store_dword v161, v160, s[92:95], 0 offen sc1
L_arr_12:
    v_mov_b32 v160, 163732
    v_mov_b32 v161, 1
    ds_write_b32 v160, v161
L_dc_10:
    s_branch L_phase2
L_k1_kv:
    v_mov_b32 v158, 0x3fb8aa3b
    v_mov_b32 v159, 0
    s_mov_b32 s44, 0x358637bd
    v_lshlrev_b32 v160, 4, v255
    s_mul_i32 s38, s22, 10240
    v_add_u32 v161, s38, v160
    s_mov_b32 s46, 0
    s_lshl_b32 s48, s20, 5
    s_lshl_b32 s49, s3, 2
    s_add_u32 s48, s48, s49
    s_add_u32 s48, s48, s22
    s_mul_i32 s48, s48, 1664
    s_add_u32 s48, s48, 21004288
    v_add_u32 v204, s48, v160
    v_add_u32 v205, 0x400, v204
    v_mov_b32 v186, 0x80000000
    v_cmp_gt_u32 vcc, 40, v255
    s_mul_i32 s49, s20, 2560
    s_mul_i32 s50, s3, 320
    s_add_u32 s49, s49, s50
    v_cndmask_b32 v205, v186, v205, vcc
    s_add_u32 s49, s49, 21856256
    v_add_u32 v206, s49, v160
    v_cmp_gt_u32 vcc, 20, v255
    s_mul_i32 s50, s22, 1664
    s_add_u32 s50, s50, 43008
    v_add_u32 v207, s50, v160
    v_cndmask_b32 v206, v186, v206, vcc
    s_mov_b32 s48, 43008
    s_mov_b32 s49, 49664
    v_lshrrev_b32 v184, 4, v255
    v_lshlrev_b32 v184, 2, v184
    v_and_b32 v185, 15, v255
    v_lshlrev_b32 v186, 2, v255
    v_add_u32 v186, 51200, v186
    v_mov_b32 v180, v186
    v_mov_b32 v181, v186
    v_mov_b32 v182, v186
    v_mov_b32 v183, v186
    s_cmp_eq_u32 s22, 0
    s_cbranch_scc0 L_k1_kve_1
    v_add_u32 v187, 0, v184
    v_mul_u32_u24 v192, 0xccd, v187
    v_lshrrev_b32 v192, 16, v192
    v_mul_u32_u24 v187, 0x50, v187
    v_lshlrev_b32 v162, 4, v192
    v_sub_u32 v188, v187, v162
    v_add_u32 v187, 1, v184
    v_mul_u32_u24 v193, 0xccd, v187
    v_lshrrev_b32 v193, 16, v193
    v_mul_u32_u24 v187, 0x50, v187
    v_lshlrev_b32 v162, 4, v193
    v_sub_u32 v189, v187, v162
    v_add_u32 v187, 2, v184
    v_mul_u32_u24 v194, 0xccd, v187
    v_lshrrev_b32 v194, 16, v194
    v_mul_u32_u24 v187, 0x50, v187
    v_lshlrev_b32 v162, 4, v194
    v_sub_u32 v190, v187, v162
    v_add_u32 v187, 3, v184
    v_mul_u32_u24 v195, 0xccd, v187
    v_lshrrev_b32 v195, 16, v195
    v_mul_u32_u24 v187, 0x50, v187
    v_lshlrev_b32 v162, 4, v195
    v_sub_u32 v191, v187, v162
    v_add_u32 v187, 64, v184
    v_mul_u32_u24 v200, 0xccd, v187
    v_lshrrev_b32 v200, 16, v200
    v_mul_u32_u24 v187, 0x50, v187
    v_lshlrev_b32 v162, 4, v200
    v_sub_u32 v196, v187, v162
    v_add_u32 v187, 65, v184
    v_mul_u32_u24 v201, 0xccd, v187
    v_lshrrev_b32 v201, 16, v201
    v_mul_u32_u24 v187, 0x50, v187
    v_lshlrev_b32 v162, 4, v201
    v_sub_u32 v197, v187, v162
    v_add_u32 v187, 66, v184
    v_mul_u32_u24 v202, 0xccd, v187
    v_lshrrev_b32 v202, 16, v202
    v_mul_u32_u24 v187, 0x50, v187
    v_lshlrev_b32 v162, 4, v202
    v_sub_u32 v198, v187, v162
    v_add_u32 v187, 67, v184
    v_mul_u32_u24 v203, 0xccd, v187
    v_lshrrev_b32 v203, 16, v203
    v_mul_u32_u24 v187, 0x50, v187
    v_lshlrev_b32 v162, 4, v203
    v_sub_u32 v199, v187, v162
    v_add_u32 v187, 0, v185
    v_mul_u32_u24 v162, 0xccd, v187
    v_lshrrev_b32 v162, 16, v162
    v_lshl_add_u32 v187, v187, 2, s48
    v_cmp_eq_u32 s[52:53], v192, v162
    v_add_u32 v164, v187, v188
    v_cmp_eq_u32 s[54:55], v193, v162
    v_add_u32 v165, v187, v189
    v_cmp_eq_u32 s[56:57], v194, v162
    v_add_u32 v166, v187, v190
    v_cmp_eq_u32 s[58:59], v195, v162
    v_add_u32 v167, v187, v191
    v_cndmask_b32 v164, v186, v164, s[52:53]
    v_cndmask_b32 v165, v186, v165, s[54:55]
    v_cndmask_b32 v166, v186, v166, s[56:57]
    v_cndmask_b32 v167, v186, v167, s[58:59]
    v_add_u32 v187, 16, v185
    v_mul_u32_u24 v162, 0xccd, v187
    v_lshrrev_b32 v162, 16, v162
    v_lshl_add_u32 v187, v187, 2, s48
    v_cmp_eq_u32 s[52:53], v192, v162
    v_add_u32 v168, v187, v188
    v_cmp_eq_u32 s[54:55], v193, v162
    v_add_u32 v169, v187, v189
    v_cmp_eq_u32 s[56:57], v194, v162
    v_add_u32 v170, v187, v190
    v_cmp_eq_u32 s[58:59], v195, v162
    v_add_u32 v171, v187, v191
    v_cndmask_b32 v168, v186, v168, s[52:53]
    v_cndmask_b32 v169, v186, v169, s[54:55]
    v_cndmask_b32 v170, v186, v170, s[56:57]
    v_cndmask_b32 v171, v186, v171, s[58:59]
    v_cmp_eq_u32 vcc, 0, v185
    v_lshl_add_u32 v187, v184, 2, s49
    v_add_u32 v187, 0, v187
    v_cndmask_b32 v187, v186, v187, vcc
    v_add_u32 v172, 0, v187
    v_add_u32 v173, 4, v187
    v_add_u32 v174, 8, v187
    v_add_u32 v175, 12, v187
    v_add_u32 v187, 48, v185
    v_mul_u32_u24 v162, 0xccd, v187
    v_lshrrev_b32 v162, 16, v162
    v_lshl_add_u32 v187, v187, 2, s48
    v_cmp_eq_u32 s[52:53], v200, v162
    v_add_u32 v176, v187, v196
    v_cmp_eq_u32 s[54:55], v201, v162
    v_add_u32 v177, v187, v197
    v_cmp_eq_u32 s[56:57], v202, v162
    v_add_u32 v178, v187, v198
    v_cmp_eq_u32 s[58:59], v203, v162
    v_add_u32 v179, v187, v199
    v_cndmask_b32 v176, v186, v176, s[52:53]
    v_cndmask_b32 v177, v186, v177, s[54:55]
    v_cndmask_b32 v178, v186, v178, s[56:57]
    v_cndmask_b32 v179, v186, v179, s[58:59]
    v_add_u32 v187, 64, v185
    v_mul_u32_u24 v162, 0xccd, v187
    v_lshrrev_b32 v162, 16, v162
    v_lshl_add_u32 v187, v187, 2, s48
    v_cmp_eq_u32 s[52:53], v200, v162
    v_add_u32 v180, v187, v196
    v_cmp_eq_u32 s[54:55], v201, v162
    v_add_u32 v181, v187, v197
    v_cmp_eq_u32 s[56:57], v202, v162
    v_add_u32 v182, v187, v198
    v_cmp_eq_u32 s[58:59], v203, v162
    v_add_u32 v183, v187, v199
    v_cndmask_b32 v180, v186, v180, s[52:53]
    v_cndmask_b32 v181, v186, v181, s[54:55]
    v_cndmask_b32 v182, v186, v182, s[56:57]
    v_cndmask_b32 v183, v186, v183, s[58:59]
    s_branch L_k1_kve_done
L_k1_kve_1:
    s_cmp_eq_u32 s22, 1
    s_cbranch_scc0 L_k1_kve_2
    v_add_u32 v187, 16, v184
    v_mul_u32_u24 v192, 0xccd, v187
    v_lshrrev_b32 v192, 16, v192
    v_mul_u32_u24 v187, 0x50, v187
    v_lshlrev_b32 v162, 4, v192
    v_sub_u32 v188, v187, v162
    v_add_u32 v187, 17, v184
    v_mul_u32_u24 v193, 0xccd, v187
    v_lshrrev_b32 v193, 16, v193
    v_mul_u32_u24 v187, 0x50, v187
    v_lshlrev_b32 v162, 4, v193
    v_sub_u32 v189, v187, v162
    v_add_u32 v187, 18, v184
    v_mul_u32_u24 v194, 0xccd, v187
    v_lshrrev_b32 v194, 16, v194
    v_mul_u32_u24 v187, 0x50, v187
    v_lshlrev_b32 v162, 4, v194
    v_sub_u32 v190, v187, v162
    v_add_u32 v187, 19, v184
    v_mul_u32_u24 v195, 0xccd, v187
    v_lshrrev_b32 v195, 16, v195
    v_mul_u32_u24 v187, 0x50, v187
    v_lshlrev_b32 v162, 4, v195
    v_sub_u32 v191, v187, v162
    v_add_u32 v187, 64, v184
    v_mul_u32_u24 v200, 0xccd, v187
    v_lshrrev_b32 v200, 16, v200
    v_mul_u32_u24 v187, 0x50, v187
    v_lshlrev_b32 v162, 4, v200
    v_sub_u32 v196, v187, v162
    v_add_u32 v187, 65, v184
    v_mul_u32_u24 v201, 0xccd, v187
    v_lshrrev_b32 v201, 16, v201
    v_mul_u32_u24 v187, 0x50, v187
    v_lshlrev_b32 v162, 4, v201
    v_sub_u32 v197, v187, v162
    v_add_u32 v187, 66, v184
    v_mul_u32_u24 v202, 0xccd, v187
    v_lshrrev_b32 v202, 16, v202
    v_mul_u32_u24 v187, 0x50, v187
    v_lshlrev_b32 v162, 4, v202
    v_sub_u32 v198, v187, v162
    v_add_u32 v187, 67, v184
    v_mul_u32_u24 v203, 0xccd, v187
    v_lshrrev_b32 v203, 16, v203
    v_mul_u32_u24 v187, 0x50, v187
    v_lshlrev_b32 v162, 4, v203
    v_sub_u32 v199, v187, v162
    v_add_u32 v187, 0, v185
    v_mul_u32_u24 v162, 0xccd, v187
    v_lshrrev_b32 v162, 16, v162
    v_lshl_add_u32 v187, v187, 2, s48
    v_cmp_eq_u32 s[52:53], v192, v162
    v_add_u32 v164, v187, v188
    v_cmp_eq_u32 s[54:55], v193, v162
    v_add_u32 v165, v187, v189
    v_cmp_eq_u32 s[56:57], v194, v162
    v_add_u32 v166, v187, v190
    v_cmp_eq_u32 s[58:59], v195, v162
    v_add_u32 v167, v187, v191
    v_cndmask_b32 v164, v186, v164, s[52:53]
    v_cndmask_b32 v165, v186, v165, s[54:55]
    v_cndmask_b32 v166, v186, v166, s[56:57]
    v_cndmask_b32 v167, v186, v167, s[58:59]
    v_add_u32 v187, 16, v185
    v_mul_u32_u24 v162, 0xccd, v187
    v_lshrrev_b32 v162, 16, v162
    v_lshl_add_u32 v187, v187, 2, s48
    v_cmp_eq_u32 s[52:53], v192, v162
    v_add_u32 v168, v187, v188
    v_cmp_eq_u32 s[54:55], v193, v162
    v_add_u32 v169, v187, v189
    v_cmp_eq_u32 s[56:57], v194, v162
    v_add_u32 v170, v187, v190
    v_cmp_eq_u32 s[58:59], v195, v162
    v_add_u32 v171, v187, v191
    v_cndmask_b32 v168, v186, v168, s[52:53]
    v_cndmask_b32 v169, v186, v169, s[54:55]
    v_cndmask_b32 v170, v186, v170, s[56:57]
    v_cndmask_b32 v171, v186, v171, s[58:59]
    v_add_u32 v187, 32, v185
    v_mul_u32_u24 v162, 0xccd, v187
    v_lshrrev_b32 v162, 16, v162
    v_lshl_add_u32 v187, v187, 2, s48
    v_cmp_eq_u32 s[52:53], v192, v162
    v_add_u32 v172, v187, v188
    v_cmp_eq_u32 s[54:55], v193, v162
    v_add_u32 v173, v187, v189
    v_cmp_eq_u32 s[56:57], v194, v162
    v_add_u32 v174, v187, v190
    v_cmp_eq_u32 s[58:59], v195, v162
    v_add_u32 v175, v187, v191
    v_cndmask_b32 v172, v186, v172, s[52:53]
    v_cndmask_b32 v173, v186, v173, s[54:55]
    v_cndmask_b32 v174, v186, v174, s[56:57]
    v_cndmask_b32 v175, v186, v175, s[58:59]
    v_cmp_eq_u32 vcc, 0, v185
    v_lshl_add_u32 v187, v184, 2, s49
    v_add_u32 v187, 64, v187
    v_cndmask_b32 v187, v186, v187, vcc
    v_add_u32 v176, 0, v187
    v_add_u32 v177, 4, v187
    v_add_u32 v178, 8, v187
    v_add_u32 v179, 12, v187
    v_cmp_eq_u32 vcc, 0, v185
    v_lshl_add_u32 v187, v184, 2, s49
    v_add_u32 v187, 256, v187
    v_cndmask_b32 v187, v186, v187, vcc
    v_add_u32 v180, 0, v187
    v_add_u32 v181, 4, v187
    v_add_u32 v182, 8, v187
    v_add_u32 v183, 12, v187
    s_branch L_k1_kve_done
L_k1_kve_2:
    s_cmp_eq_u32 s22, 2
    s_cbranch_scc0 L_k1_kve_3
    v_add_u32 v187, 32, v184
    v_mul_u32_u24 v192, 0xccd, v187
    v_lshrrev_b32 v192, 16, v192
    v_mul_u32_u24 v187, 0x50, v187
    v_lshlrev_b32 v162, 4, v192
    v_sub_u32 v188, v187, v162
    v_add_u32 v187, 33, v184
    v_mul_u32_u24 v193, 0xccd, v187
    v_lshrrev_b32 v193, 16, v193
    v_mul_u32_u24 v187, 0x50, v187
    v_lshlrev_b32 v162, 4, v193
    v_sub_u32 v189, v187, v162
    v_add_u32 v187, 34, v184
    v_mul_u32_u24 v194, 0xccd, v187
    v_lshrrev_b32 v194, 16, v194
    v_mul_u32_u24 v187, 0x50, v187
    v_lshlrev_b32 v162, 4, v194
    v_sub_u32 v190, v187, v162
    v_add_u32 v187, 35, v184
    v_mul_u32_u24 v195, 0xccd, v187
    v_lshrrev_b32 v195, 16, v195
    v_mul_u32_u24 v187, 0x50, v187
    v_lshlrev_b32 v162, 4, v195
    v_sub_u32 v191, v187, v162
    v_add_u32 v187, 16, v185
    v_mul_u32_u24 v162, 0xccd, v187
    v_lshrrev_b32 v162, 16, v162
    v_lshl_add_u32 v187, v187, 2, s48
    v_cmp_eq_u32 s[52:53], v192, v162
    v_add_u32 v164, v187, v188
    v_cmp_eq_u32 s[54:55], v193, v162
    v_add_u32 v165, v187, v189
    v_cmp_eq_u32 s[56:57], v194, v162
    v_add_u32 v166, v187, v190
    v_cmp_eq_u32 s[58:59], v195, v162
    v_add_u32 v167, v187, v191
    v_cndmask_b32 v164, v186, v164, s[52:53]
    v_cndmask_b32 v165, v186, v165, s[54:55]
    v_cndmask_b32 v166, v186, v166, s[56:57]
    v_cndmask_b32 v167, v186, v167, s[58:59]
    v_add_u32 v187, 32, v185
    v_mul_u32_u24 v162, 0xccd, v187
    v_lshrrev_b32 v162, 16, v162
    v_lshl_add_u32 v187, v187, 2, s48
    v_cmp_eq_u32 s[52:53], v192, v162
    v_add_u32 v168, v187, v188
    v_cmp_eq_u32 s[54:55], v193, v162
    v_add_u32 v169, v187, v189
    v_cmp_eq_u32 s[56:57], v194, v162
    v_add_u32 v170, v187, v190
    v_cmp_eq_u32 s[58:59], v195, v162
    v_add_u32 v171, v187, v191
    v_cndmask_b32 v168, v186, v168, s[52:53]
    v_cndmask_b32 v169, v186, v169, s[54:55]
    v_cndmask_b32 v170, v186, v170, s[56:57]
    v_cndmask_b32 v171, v186, v171, s[58:59]
    v_add_u32 v187, 48, v185
    v_mul_u32_u24 v162, 0xccd, v187
    v_lshrrev_b32 v162, 16, v162
    v_lshl_add_u32 v187, v187, 2, s48
    v_cmp_eq_u32 s[52:53], v192, v162
    v_add_u32 v172, v187, v188
    v_cmp_eq_u32 s[54:55], v193, v162
    v_add_u32 v173, v187, v189
    v_cmp_eq_u32 s[56:57], v194, v162
    v_add_u32 v174, v187, v190
    v_cmp_eq_u32 s[58:59], v195, v162
    v_add_u32 v175, v187, v191
    v_cndmask_b32 v172, v186, v172, s[52:53]
    v_cndmask_b32 v173, v186, v173, s[54:55]
    v_cndmask_b32 v174, v186, v174, s[56:57]
    v_cndmask_b32 v175, v186, v175, s[58:59]
    v_cmp_eq_u32 vcc, 0, v185
    v_lshl_add_u32 v187, v184, 2, s49
    v_add_u32 v187, 128, v187
    v_cndmask_b32 v187, v186, v187, vcc
    v_add_u32 v176, 0, v187
    v_add_u32 v177, 4, v187
    v_add_u32 v178, 8, v187
    v_add_u32 v179, 12, v187
    s_branch L_k1_kve_done
L_k1_kve_3:
    v_add_u32 v187, 48, v184
    v_mul_u32_u24 v192, 0xccd, v187
    v_lshrrev_b32 v192, 16, v192
    v_mul_u32_u24 v187, 0x50, v187
    v_lshlrev_b32 v162, 4, v192
    v_sub_u32 v188, v187, v162
    v_add_u32 v187, 49, v184
    v_mul_u32_u24 v193, 0xccd, v187
    v_lshrrev_b32 v193, 16, v193
    v_mul_u32_u24 v187, 0x50, v187
    v_lshlrev_b32 v162, 4, v193
    v_sub_u32 v189, v187, v162
    v_add_u32 v187, 50, v184
    v_mul_u32_u24 v194, 0xccd, v187
    v_lshrrev_b32 v194, 16, v194
    v_mul_u32_u24 v187, 0x50, v187
    v_lshlrev_b32 v162, 4, v194
    v_sub_u32 v190, v187, v162
    v_add_u32 v187, 51, v184
    v_mul_u32_u24 v195, 0xccd, v187
    v_lshrrev_b32 v195, 16, v195
    v_mul_u32_u24 v187, 0x50, v187
    v_lshlrev_b32 v162, 4, v195
    v_sub_u32 v191, v187, v162
    v_add_u32 v187, 32, v185
    v_mul_u32_u24 v162, 0xccd, v187
    v_lshrrev_b32 v162, 16, v162
    v_lshl_add_u32 v187, v187, 2, s48
    v_cmp_eq_u32 s[52:53], v192, v162
    v_add_u32 v164, v187, v188
    v_cmp_eq_u32 s[54:55], v193, v162
    v_add_u32 v165, v187, v189
    v_cmp_eq_u32 s[56:57], v194, v162
    v_add_u32 v166, v187, v190
    v_cmp_eq_u32 s[58:59], v195, v162
    v_add_u32 v167, v187, v191
    v_cndmask_b32 v164, v186, v164, s[52:53]
    v_cndmask_b32 v165, v186, v165, s[54:55]
    v_cndmask_b32 v166, v186, v166, s[56:57]
    v_cndmask_b32 v167, v186, v167, s[58:59]
    v_add_u32 v187, 48, v185
    v_mul_u32_u24 v162, 0xccd, v187
    v_lshrrev_b32 v162, 16, v162
    v_lshl_add_u32 v187, v187, 2, s48
    v_cmp_eq_u32 s[52:53], v192, v162
    v_add_u32 v168, v187, v188
    v_cmp_eq_u32 s[54:55], v193, v162
    v_add_u32 v169, v187, v189
    v_cmp_eq_u32 s[56:57], v194, v162
    v_add_u32 v170, v187, v190
    v_cmp_eq_u32 s[58:59], v195, v162
    v_add_u32 v171, v187, v191
    v_cndmask_b32 v168, v186, v168, s[52:53]
    v_cndmask_b32 v169, v186, v169, s[54:55]
    v_cndmask_b32 v170, v186, v170, s[56:57]
    v_cndmask_b32 v171, v186, v171, s[58:59]
    v_add_u32 v187, 64, v185
    v_mul_u32_u24 v162, 0xccd, v187
    v_lshrrev_b32 v162, 16, v162
    v_lshl_add_u32 v187, v187, 2, s48
    v_cmp_eq_u32 s[52:53], v192, v162
    v_add_u32 v172, v187, v188
    v_cmp_eq_u32 s[54:55], v193, v162
    v_add_u32 v173, v187, v189
    v_cmp_eq_u32 s[56:57], v194, v162
    v_add_u32 v174, v187, v190
    v_cmp_eq_u32 s[58:59], v195, v162
    v_add_u32 v175, v187, v191
    v_cndmask_b32 v172, v186, v172, s[52:53]
    v_cndmask_b32 v173, v186, v173, s[54:55]
    v_cndmask_b32 v174, v186, v174, s[56:57]
    v_cndmask_b32 v175, v186, v175, s[58:59]
    v_cmp_eq_u32 vcc, 0, v185
    v_lshl_add_u32 v187, v184, 2, s49
    v_add_u32 v187, 192, v187
    v_cndmask_b32 v187, v186, v187, vcc
    v_add_u32 v176, 0, v187
    v_add_u32 v177, 4, v187
    v_add_u32 v178, 8, v187
    v_add_u32 v179, 12, v187
L_k1_kve_done:
    s_mov_b32 s40, 0
    s_mov_b32 s51, 0
    s_barrier
    ds_read_b64_tr_b16 v[96:97], v154 offset:0
    ds_read_b64_tr_b16 v[98:99], v154 offset:256
    ds_read_b128 v[80:83], v152 offset:0
    ds_read_b128 v[84:87], v152 offset:2048
    ds_read_b128 v[88:91], v152 offset:4096
    ds_read_b128 v[92:95], v152 offset:6144
    ds_read_b64_tr_b16 v[100:101], v155 offset:0
    ds_read_b64_tr_b16 v[102:103], v155 offset:256
    ds_read_b64_tr_b16 v[104:105], v154 offset:1024
    ds_read_b64_tr_b16 v[106:107], v154 offset:1280
    ds_read_b64_tr_b16 v[108:109], v155 offset:1024
    ds_read_b64_tr_b16 v[110:111], v155 offset:1280
    ds_read_b64_tr_b16 v[112:113], v154 offset:2048
    ds_read_b64_tr_b16 v[114:115], v154 offset:2304
    s_waitcnt lgkmcnt(0)
L_k1_main_nm:
    v_mfma_f32_16x16x32_bf16 v[0:3], v[80:83], v[96:99], v[0:3]
    ds_read_b64_tr_b16 v[132:133], v154 offset:10240
    v_mfma_f32_16x16x32_bf16 v[20:23], v[84:87], v[96:99], v[20:23]
    ds_read_b64_tr_b16 v[134:135], v154 offset:10496
    v_mfma_f32_16x16x32_bf16 v[40:43], v[88:91], v[96:99], v[40:43]
    ds_read_b128 v[116:119], v153 offset:0
    v_mfma_f32_16x16x32_bf16 v[60:63], v[92:95], v[96:99], v[60:63]
    ds_read_b128 v[120:123], v153 offset:2048
    v_mfma_f32_16x16x32_bf16 v[4:7], v[80:83], v[100:103], v[4:7]
    ds_read_b128 v[124:127], v153 offset:4096
    v_mfma_f32_16x16x32_bf16 v[24:27], v[84:87], v[100:103], v[24:27]
    ds_read_b128 v[128:131], v153 offset:6144
    v_mfma_f32_16x16x32_bf16 v[44:47], v[88:91], v[100:103], v[44:47]
    ds_read_b64_tr_b16 v[136:137], v155 offset:10240
    v_mfma_f32_16x16x32_bf16 v[64:67], v[92:95], v[100:103], v[64:67]
    ds_read_b64_tr_b16 v[138:139], v155 offset:10496
    v_mfma_f32_16x16x32_bf16 v[8:11], v[80:83], v[104:107], v[8:11]
    ds_read_b64_tr_b16 v[140:141], v154 offset:11264
    v_mfma_f32_16x16x32_bf16 v[28:31], v[84:87], v[104:107], v[28:31]
    ds_read_b64_tr_b16 v[142:143], v154 offset:11520
    v_mfma_f32_16x16x32_bf16 v[48:51], v[88:91], v[104:107], v[48:51]
    ds_read_b64_tr_b16 v[144:145], v155 offset:11264
    v_mfma_f32_16x16x32_bf16 v[68:71], v[92:95], v[104:107], v[68:71]
    ds_read_b64_tr_b16 v[146:147], v155 offset:11520
    v_mfma_f32_16x16x32_bf16 v[12:15], v[80:83], v[108:111], v[12:15]
    ds_read_b64_tr_b16 v[148:149], v154 offset:12288
    v_mfma_f32_16x16x32_bf16 v[32:35], v[84:87], v[108:111], v[32:35]
    ds_read_b64_tr_b16 v[150:151], v154 offset:12544
    s_add_u32 s40, s40, 1
    s_and_b32 s41, s40, 3
    v_mfma_f32_16x16x32_bf16 v[52:55], v[88:91], v[108:111], v[52:55]
    s_add_u32 s51, s51, 1
    s_movk_i32 s42, 16384
    v_mfma_f32_16x16x32_bf16 v[72:75], v[92:95], v[108:111], v[72:75]
    s_movk_i32 s43, 20480
    s_cmp_eq_u32 s41, 0
    v_mfma_f32_16x16x32_bf16 v[16:19], v[80:83], v[112:115], v[16:19]
    s_cselect_b32 s43, 0xffff1000, s43
    s_cmp_eq_u32 s51, 3
    v_mfma_f32_16x16x32_bf16 v[36:39], v[84:87], v[112:115], v[36:39]
    s_cselect_b32 s42, 0xffff8000, s42
    s_cselect_b32 s51, 0, s51
    v_mfma_f32_16x16x32_bf16 v[56:59], v[88:91], v[112:115], v[56:59]
    v_add_u32 v152, s42, v152
    v_add_u32 v153, s42, v153
    v_mfma_f32_16x16x32_bf16 v[76:79], v[92:95], v[112:115], v[76:79]
    v_add_u32 v154, s43, v154
    v_add_u32 v155, s43, v155
    s_cmp_eq_u32 s40, 10
    s_waitcnt lgkmcnt(0)
    s_cbranch_scc1 L_k1_nobar_nm
    s_barrier
L_k1_nobar_nm:
    v_mfma_f32_16x16x32_bf16 v[0:3], v[116:119], v[132:135], v[0:3]
    ds_read_b64_tr_b16 v[96:97], v154 offset:0
    v_mfma_f32_16x16x32_bf16 v[20:23], v[120:123], v[132:135], v[20:23]
    ds_read_b64_tr_b16 v[98:99], v154 offset:256
    v_mfma_f32_16x16x32_bf16 v[40:43], v[124:127], v[132:135], v[40:43]
    ds_read_b128 v[80:83], v152 offset:0
    v_mfma_f32_16x16x32_bf16 v[60:63], v[128:131], v[132:135], v[60:63]
    ds_read_b128 v[84:87], v152 offset:2048
    v_mfma_f32_16x16x32_bf16 v[4:7], v[116:119], v[136:139], v[4:7]
    ds_read_b128 v[88:91], v152 offset:4096
    v_mfma_f32_16x16x32_bf16 v[24:27], v[120:123], v[136:139], v[24:27]
    ds_read_b128 v[92:95], v152 offset:6144
    v_mfma_f32_16x16x32_bf16 v[44:47], v[124:127], v[136:139], v[44:47]
    ds_read_b64_tr_b16 v[100:101], v155 offset:0
    v_mfma_f32_16x16x32_bf16 v[64:67], v[128:131], v[136:139], v[64:67]
    ds_read_b64_tr_b16 v[102:103], v155 offset:256
    v_mfma_f32_16x16x32_bf16 v[8:11], v[116:119], v[140:143], v[8:11]
    ds_read_b64_tr_b16 v[104:105], v154 offset:1024
    v_mfma_f32_16x16x32_bf16 v[28:31], v[120:123], v[140:143], v[28:31]
    ds_read_b64_tr_b16 v[106:107], v154 offset:1280
    v_mfma_f32_16x16x32_bf16 v[48:51], v[124:127], v[140:143], v[48:51]
    ds_read_b64_tr_b16 v[108:109], v155 offset:1024
    v_mfma_f32_16x16x32_bf16 v[68:71], v[128:131], v[140:143], v[68:71]
    ds_read_b64_tr_b16 v[110:111], v155 offset:1280
    v_mfma_f32_16x16x32_bf16 v[12:15], v[116:119], v[144:147], v[12:15]
    ds_read_b64_tr_b16 v[112:113], v154 offset:2048
    v_mfma_f32_16x16x32_bf16 v[32:35], v[120:123], v[144:147], v[32:35]
    ds_read_b64_tr_b16 v[114:115], v154 offset:2304
    v_mfma_f32_16x16x32_bf16 v[52:55], v[124:127], v[144:147], v[52:55]
    v_mfma_f32_16x16x32_bf16 v[72:75], v[128:131], v[144:147], v[72:75]
    v_mfma_f32_16x16x32_bf16 v[16:19], v[116:119], v[148:151], v[16:19]
    v_mfma_f32_16x16x32_bf16 v[36:39], v[120:123], v[148:151], v[36:39]
    v_mfma_f32_16x16x32_bf16 v[56:59], v[124:127], v[148:151], v[56:59]
    v_mfma_f32_16x16x32_bf16 v[76:79], v[128:131], v[148:151], v[76:79]
    s_waitcnt lgkmcnt(0)
    s_cbranch_scc0 L_k1_main_nm
    s_barrier
    v_mov_b32 v120, 0x3f803f80
    v_mov_b32 v121, 0x3f803f80
    v_mov_b32 v122, 0x3f803f80
    v_mov_b32 v123, 0x3f803f80
    ds_write_b128 v160, v[120:123] offset:40960
L_k1_kv_pack:
    s_set_gpr_idx_on s46, 0x3
    s_nop 0
    v_cvt_pk_bf16_f32 v124, v12, v13
    v_cvt_pk_bf16_f32 v125, v14, v15
    v_cvt_pk_bf16_f32 v126, v32, v33
    v_cvt_pk_bf16_f32 v127, v34, v35
    v_cvt_pk_bf16_f32 v128, v16, v17
    v_cvt_pk_bf16_f32 v129, v18, v19
    v_cvt_pk_bf16_f32 v130, v36, v37
    v_cvt_pk_bf16_f32 v131, v38, v39
    s_set_gpr_idx_off
    ds_write_b128 v161, v[124:127] offset:6144
    ds_write_b128 v161, v[128:131] offset:8192
    s_set_gpr_idx_on s46, 0x1
    s_nop 0
    v_mul_f32 v80, v0, v158
    v_max_f32 v96, v0, v159
    v_mul_f32 v81, v1, v158
    v_max_f32 v97, v1, v159
    v_mul_f32 v82, v2, v158
    v_max_f32 v98, v2, v159
    v_mul_f32 v83, v3, v158
    v_max_f32 v99, v3, v159
    v_mul_f32 v84, v20, v158
    v_max_f32 v100, v20, v159
    v_mul_f32 v85, v21, v158
    v_max_f32 v101, v21, v159
    v_mul_f32 v86, v22, v158
    v_max_f32 v102, v22, v159
    v_mul_f32 v87, v23, v158
    v_max_f32 v103, v23, v159
    v_mul_f32 v88, v4, v158
    v_max_f32 v104, v4, v159
    v_mul_f32 v89, v5, v158
    v_max_f32 v105, v5, v159
    v_mul_f32 v90, v6, v158
    v_max_f32 v106, v6, v159
    v_mul_f32 v91, v7, v158
    v_max_f32 v107, v7, v159
    v_mul_f32 v92, v24, v158
    v_max_f32 v108, v24, v159
    v_mul_f32 v93, v25, v158
    v_max_f32 v109, v25, v159
    v_mul_f32 v94, v26, v158
    v_max_f32 v110, v26, v159
    v_mul_f32 v95, v27, v158
    v_max_f32 v111, v27, v159
    s_set_gpr_idx_off
    v_exp_f32_e64 v80, v80 clamp
    v_exp_f32_e64 v81, v81 clamp
    v_exp_f32_e64 v82, v82 clamp
    v_exp_f32_e64 v83, v83 clamp
    v_exp_f32_e64 v84, v84 clamp
    v_exp_f32_e64 v85, v85 clamp
    v_exp_f32_e64 v86, v86 clamp
    v_exp_f32_e64 v87, v87 clamp
    v_exp_f32_e64 v88, v88 clamp
    v_exp_f32_e64 v89, v89 clamp
    v_exp_f32_e64 v90, v90 clamp
    v_exp_f32_e64 v91, v91 clamp
    v_exp_f32_e64 v92, v92 clamp
    v_exp_f32_e64 v93, v93 clamp
    v_exp_f32_e64 v94, v94 clamp
    v_exp_f32_e64 v95, v95 clamp
    v_pk_add_f32 v[80:81], v[80:81], s[44:45] op_sel_hi:[1,0]
    v_pk_add_f32 v[82:83], v[82:83], s[44:45] op_sel_hi:[1,0]
    v_pk_add_f32 v[84:85], v[84:85], s[44:45] op_sel_hi:[1,0]
    v_pk_add_f32 v[86:87], v[86:87], s[44:45] op_sel_hi:[1,0]
    v_pk_add_f32 v[88:89], v[88:89], s[44:45] op_sel_hi:[1,0]
    v_pk_add_f32 v[90:91], v[90:91], s[44:45] op_sel_hi:[1,0]
    v_pk_add_f32 v[92:93], v[92:93], s[44:45] op_sel_hi:[1,0]
    v_pk_add_f32 v[94:95], v[94:95], s[44:45] op_sel_hi:[1,0]
    v_pk_add_f32 v[96:97], v[96:97], v[80:81]
    v_pk_add_f32 v[98:99], v[98:99], v[82:83]
    v_pk_add_f32 v[100:101], v[100:101], v[84:85]
    v_pk_add_f32 v[102:103], v[102:103], v[86:87]
    v_pk_add_f32 v[104:105], v[104:105], v[88:89]
    v_pk_add_f32 v[106:107], v[106:107], v[90:91]
    v_pk_add_f32 v[108:109], v[108:109], v[92:93]
    v_pk_add_f32 v[110:111], v[110:111], v[94:95]
    v_cvt_pk_bf16_f32 v144, v96, v97
    v_cvt_pk_bf16_f32 v145, v98, v99
    v_cvt_pk_bf16_f32 v146, v100, v101
    v_cvt_pk_bf16_f32 v147, v102, v103
    ds_write_b128 v161, v[144:147] offset:0
    v_cvt_pk_bf16_f32 v148, v104, v105
    v_cvt_pk_bf16_f32 v149, v106, v107
    v_cvt_pk_bf16_f32 v150, v108, v109
    v_cvt_pk_bf16_f32 v151, v110, v111
    ds_write_b128 v161, v[148:151] offset:2048
    s_cmp_eq_u32 s37, 1
    s_cbranch_scc1 L_k1_kv_raw2
    s_set_gpr_idx_on s46, 0x1
    s_nop 0
    v_mul_f32 v80, v8, v158
    v_max_f32 v112, v8, v159
    v_mul_f32 v81, v9, v158
    v_max_f32 v113, v9, v159
    v_mul_f32 v82, v10, v158
    v_max_f32 v114, v10, v159
    v_mul_f32 v83, v11, v158
    v_max_f32 v115, v11, v159
    v_mul_f32 v84, v28, v158
    v_max_f32 v116, v28, v159
    v_mul_f32 v85, v29, v158
    v_max_f32 v117, v29, v159
    v_mul_f32 v86, v30, v158
    v_max_f32 v118, v30, v159
    v_mul_f32 v87, v31, v158
    v_max_f32 v119, v31, v159
    s_set_gpr_idx_off
    v_exp_f32_e64 v80, v80 clamp
    v_exp_f32_e64 v81, v81 clamp
    v_exp_f32_e64 v82, v82 clamp
    v_exp_f32_e64 v83, v83 clamp
    v_exp_f32_e64 v84, v84 clamp
    v_exp_f32_e64 v85, v85 clamp
    v_exp_f32_e64 v86, v86 clamp
    v_exp_f32_e64 v87, v87 clamp
    v_pk_add_f32 v[80:81], v[80:81], s[44:45] op_sel_hi:[1,0]
    v_pk_add_f32 v[82:83], v[82:83], s[44:45] op_sel_hi:[1,0]
    v_pk_add_f32 v[84:85], v[84:85], s[44:45] op_sel_hi:[1,0]
    v_pk_add_f32 v[86:87], v[86:87], s[44:45] op_sel_hi:[1,0]
    v_pk_add_f32 v[112:113], v[112:113], v[80:81]
    v_pk_add_f32 v[114:115], v[114:115], v[82:83]
    v_pk_add_f32 v[116:117], v[116:117], v[84:85]
    v_pk_add_f32 v[118:119], v[118:119], v[86:87]
    v_cvt_pk_bf16_f32 v144, v112, v113
    v_cvt_pk_bf16_f32 v145, v114, v115
    v_cvt_pk_bf16_f32 v146, v116, v117
    v_cvt_pk_bf16_f32 v147, v118, v119
    ds_write_b128 v161, v[144:147] offset:4096
    s_branch L_k1_kv_t2
L_k1_kv_raw2:
    s_set_gpr_idx_on s46, 0x3
    s_nop 0
    v_cvt_pk_bf16_f32 v120, v8, v9
    v_cvt_pk_bf16_f32 v121, v10, v11
    v_cvt_pk_bf16_f32 v122, v28, v29
    v_cvt_pk_bf16_f32 v123, v30, v31
    s_set_gpr_idx_off
    ds_write_b128 v161, v[120:123] offset:4096
L_k1_kv_t2:
    v_add_u32 v161, 0x400, v161
    s_add_u32 s46, s46, 40
    s_cmp_lt_u32 s46, 80
    s_cbranch_scc1 L_k1_kv_pack
    s_waitcnt lgkmcnt(0)
    s_add_u32 s98, s98, 1
    s_lshl_b32 s99, s22, 2
    s_add_u32 s99, s99, 163712
    v_mov_b32 v212, s99
    v_mov_b32 v213, s98
    s_waitcnt lgkmcnt(0)
    ds_write_b32 v212, v213
    v_mov_b32 v212, 163712
L_csync_13:
    ds_read_b128 v[208:211], v212
    s_waitcnt lgkmcnt(0)
    v_min_u32 v208, v208, v209
    v_min_u32 v210, v210, v211
    v_min_u32 v208, v208, v210
    v_cmp_le_u32 vcc, v213, v208
    s_nop 0
    s_cbranch_vccz L_csync_13
    s_cmp_eq_u32 s22, 0
    s_cbranch_scc0 L_k1_kvj_1
    ds_read_b128 v[96:99], v160 offset:40960
    ds_read_b128 v[0:3], v160 offset:0
    ds_read_b128 v[16:19], v160 offset:12288
    ds_read_b128 v[32:35], v160 offset:6144
    ds_read_b128 v[48:51], v160 offset:8192
    ds_read_b128 v[64:67], v160 offset:16384
    ds_read_b128 v[80:83], v160 offset:18432
    ds_read_b128 v[4:7], v160 offset:1024
    ds_read_b128 v[20:23], v160 offset:13312
    ds_read_b128 v[36:39], v160 offset:7168
    ds_read_b128 v[52:55], v160 offset:9216
    ds_read_b128 v[68:71], v160 offset:17408
    ds_read_b128 v[84:87], v160 offset:19456
    s_waitcnt lgkmcnt(6)
    ds_read_b128 v[8:11], v160 offset:20480
    ds_read_b128 v[24:27], v160 offset:32768
    ds_read_b128 v[40:43], v160 offset:26624
    ds_read_b128 v[56:59], v160 offset:28672
    ds_read_b128 v[72:75], v160 offset:36864
    ds_read_b128 v[88:91], v160 offset:38912
    v_mfma_f32_16x16x32_bf16 v[100:103], v[0:3], v[32:35], 0
    v_mfma_f32_16x16x32_bf16 v[104:107], v[0:3], v[48:51], 0
    v_mfma_f32_16x16x32_bf16 v[108:111], v[0:3], v[96:99], 0
    v_mfma_f32_16x16x32_bf16 v[112:115], v[16:19], v[64:67], 0
    v_mfma_f32_16x16x32_bf16 v[116:119], v[16:19], v[80:83], 0
    s_waitcnt lgkmcnt(6)
    ds_read_b128 v[12:15], v160 offset:21504
    ds_read_b128 v[28:31], v160 offset:33792
    ds_read_b128 v[44:47], v160 offset:27648
    ds_read_b128 v[60:63], v160 offset:29696
    ds_read_b128 v[76:79], v160 offset:37888
    ds_read_b128 v[92:95], v160 offset:39936
    v_mfma_f32_16x16x32_bf16 v[100:103], v[4:7], v[36:39], v[100:103]
    v_mfma_f32_16x16x32_bf16 v[104:107], v[4:7], v[52:55], v[104:107]
    v_mfma_f32_16x16x32_bf16 v[108:111], v[4:7], v[96:99], v[108:111]
    v_mfma_f32_16x16x32_bf16 v[112:115], v[20:23], v[68:71], v[112:115]
    v_mfma_f32_16x16x32_bf16 v[116:119], v[20:23], v[84:87], v[116:119]
    s_waitcnt lgkmcnt(6)
    v_mfma_f32_16x16x32_bf16 v[100:103], v[8:11], v[40:43], v[100:103]
    v_mfma_f32_16x16x32_bf16 v[104:107], v[8:11], v[56:59], v[104:107]
    v_mfma_f32_16x16x32_bf16 v[108:111], v[8:11], v[96:99], v[108:111]
    v_mfma_f32_16x16x32_bf16 v[112:115], v[24:27], v[72:75], v[112:115]
    v_mfma_f32_16x16x32_bf16 v[116:119], v[24:27], v[88:91], v[116:119]
    s_waitcnt lgkmcnt(0)
    v_mfma_f32_16x16x32_bf16 v[100:103], v[12:15], v[44:47], v[100:103]
    v_mfma_f32_16x16x32_bf16 v[104:107], v[12:15], v[60:63], v[104:107]
    v_mfma_f32_16x16x32_bf16 v[108:111], v[12:15], v[96:99], v[108:111]
    v_mfma_f32_16x16x32_bf16 v[112:115], v[28:31], v[76:79], v[112:115]
    v_mfma_f32_16x16x32_bf16 v[116:119], v[28:31], v[92:95], v[116:119]
    s_nop 4
    ds_write_b32 v164, v100
    ds_write_b32 v165, v101
    ds_write_b32 v166, v102
    ds_write_b32 v167, v103
    ds_write_b32 v168, v104
    ds_write_b32 v169, v105
    ds_write_b32 v170, v106
    ds_write_b32 v171, v107
    ds_write_b32 v172, v108
    ds_write_b32 v173, v109
    ds_write_b32 v174, v110
    ds_write_b32 v175, v111
    ds_write_b32 v176, v112
    ds_write_b32 v177, v113
    ds_write_b32 v178, v114
    ds_write_b32 v179, v115
    s_nop 3
    ds_write_b32 v180, v116
    ds_write_b32 v181, v117
    ds_write_b32 v182, v118
    ds_write_b32 v183, v119
    s_branch L_k1_kv_out
L_k1_kvj_1:
    s_cmp_eq_u32 s22, 1
    s_cbranch_scc0 L_k1_kvj_2
    ds_read_b128 v[96:99], v160 offset:40960
    ds_read_b128 v[0:3], v160 offset:2048
    ds_read_b128 v[16:19], v160 offset:12288
    ds_read_b128 v[32:35], v160 offset:6144
    ds_read_b128 v[48:51], v160 offset:8192
    ds_read_b128 v[64:67], v160 offset:14336
    ds_read_b128 v[4:7], v160 offset:3072
    ds_read_b128 v[20:23], v160 offset:13312
    ds_read_b128 v[36:39], v160 offset:7168
    ds_read_b128 v[52:55], v160 offset:9216
    ds_read_b128 v[68:71], v160 offset:15360
    s_waitcnt lgkmcnt(5)
    ds_read_b128 v[8:11], v160 offset:22528
    ds_read_b128 v[24:27], v160 offset:32768
    ds_read_b128 v[40:43], v160 offset:26624
    ds_read_b128 v[56:59], v160 offset:28672
    ds_read_b128 v[72:75], v160 offset:34816
    v_mfma_f32_16x16x32_bf16 v[100:103], v[0:3], v[32:35], 0
    v_mfma_f32_16x16x32_bf16 v[104:107], v[0:3], v[48:51], 0
    v_mfma_f32_16x16x32_bf16 v[108:111], v[0:3], v[64:67], 0
    v_mfma_f32_16x16x32_bf16 v[112:115], v[0:3], v[96:99], 0
    v_mfma_f32_16x16x32_bf16 v[116:119], v[16:19], v[96:99], 0
    s_waitcnt lgkmcnt(5)
    ds_read_b128 v[12:15], v160 offset:23552
    ds_read_b128 v[28:31], v160 offset:33792
    ds_read_b128 v[44:47], v160 offset:27648
    ds_read_b128 v[60:63], v160 offset:29696
    ds_read_b128 v[76:79], v160 offset:35840
    v_mfma_f32_16x16x32_bf16 v[100:103], v[4:7], v[36:39], v[100:103]
    v_mfma_f32_16x16x32_bf16 v[104:107], v[4:7], v[52:55], v[104:107]
    v_mfma_f32_16x16x32_bf16 v[108:111], v[4:7], v[68:71], v[108:111]
    v_mfma_f32_16x16x32_bf16 v[112:115], v[4:7], v[96:99], v[112:115]
    v_mfma_f32_16x16x32_bf16 v[116:119], v[20:23], v[96:99], v[116:119]
    s_waitcnt lgkmcnt(5)
    v_mfma_f32_16x16x32_bf16 v[100:103], v[8:11], v[40:43], v[100:103]
    v_mfma_f32_16x16x32_bf16 v[104:107], v[8:11], v[56:59], v[104:107]
    v_mfma_f32_16x16x32_bf16 v[108:111], v[8:11], v[72:75], v[108:111]
    v_mfma_f32_16x16x32_bf16 v[112:115], v[8:11], v[96:99], v[112:115]
    v_mfma_f32_16x16x32_bf16 v[116:119], v[24:27], v[96:99], v[116:119]
    s_waitcnt lgkmcnt(0)
    v_mfma_f32_16x16x32_bf16 v[100:103], v[12:15], v[44:47], v[100:103]
    v_mfma_f32_16x16x32_bf16 v[104:107], v[12:15], v[60:63], v[104:107]
    v_mfma_f32_16x16x32_bf16 v[108:111], v[12:15], v[76:79], v[108:111]
    v_mfma_f32_16x16x32_bf16 v[112:115], v[12:15], v[96:99], v[112:115]
    v_mfma_f32_16x16x32_bf16 v[116:119], v[28:31], v[96:99], v[116:119]
    s_nop 4
    ds_write_b32 v164, v100
    ds_write_b32 v165, v101
    ds_write_b32 v166, v102
    ds_write_b32 v167, v103
    ds_write_b32 v168, v104
    ds_write_b32 v169, v105
    ds_write_b32 v170, v106
    ds_write_b32 v171, v107
    ds_write_b32 v172, v108
    ds_write_b32 v173, v109
    ds_write_b32 v174, v110
    ds_write_b32 v175, v111
    ds_write_b32 v176, v112
    ds_write_b32 v177, v113
    ds_write_b32 v178, v114
    ds_write_b32 v179, v115
    s_nop 3
    ds_write_b32 v180, v116
    ds_write_b32 v181, v117
    ds_write_b32 v182, v118
    ds_write_b32 v183, v119
    s_branch L_k1_kv_out
L_k1_kvj_2:
    s_cmp_eq_u32 s22, 2
    s_cbranch_scc0 L_k1_kvj_3
    ds_read_b128 v[96:99], v160 offset:40960
    ds_read_b128 v[0:3], v160 offset:4096
    ds_read_b128 v[32:35], v160 offset:8192
    ds_read_b128 v[48:51], v160 offset:14336
    ds_read_b128 v[64:67], v160 offset:16384
    ds_read_b128 v[4:7], v160 offset:5120
    ds_read_b128 v[36:39], v160 offset:9216
    ds_read_b128 v[52:55], v160 offset:15360
    ds_read_b128 v[68:71], v160 offset:17408
    s_waitcnt lgkmcnt(4)
    ds_read_b128 v[8:11], v160 offset:24576
    ds_read_b128 v[40:43], v160 offset:28672
    ds_read_b128 v[56:59], v160 offset:34816
    ds_read_b128 v[72:75], v160 offset:36864
    v_mfma_f32_16x16x32_bf16 v[100:103], v[0:3], v[32:35], 0
    v_mfma_f32_16x16x32_bf16 v[104:107], v[0:3], v[48:51], 0
    v_mfma_f32_16x16x32_bf16 v[108:111], v[0:3], v[64:67], 0
    v_mfma_f32_16x16x32_bf16 v[112:115], v[0:3], v[96:99], 0
    s_waitcnt lgkmcnt(4)
    ds_read_b128 v[12:15], v160 offset:25600
    ds_read_b128 v[44:47], v160 offset:29696
    ds_read_b128 v[60:63], v160 offset:35840
    ds_read_b128 v[76:79], v160 offset:37888
    v_mfma_f32_16x16x32_bf16 v[100:103], v[4:7], v[36:39], v[100:103]
    v_mfma_f32_16x16x32_bf16 v[104:107], v[4:7], v[52:55], v[104:107]
    v_mfma_f32_16x16x32_bf16 v[108:111], v[4:7], v[68:71], v[108:111]
    v_mfma_f32_16x16x32_bf16 v[112:115], v[4:7], v[96:99], v[112:115]
    s_waitcnt lgkmcnt(4)
    v_mfma_f32_16x16x32_bf16 v[100:103], v[8:11], v[40:43], v[100:103]
    v_mfma_f32_16x16x32_bf16 v[104:107], v[8:11], v[56:59], v[104:107]
    v_mfma_f32_16x16x32_bf16 v[108:111], v[8:11], v[72:75], v[108:111]
    v_mfma_f32_16x16x32_bf16 v[112:115], v[8:11], v[96:99], v[112:115]
    s_waitcnt lgkmcnt(0)
    v_mfma_f32_16x16x32_bf16 v[100:103], v[12:15], v[44:47], v[100:103]
    v_mfma_f32_16x16x32_bf16 v[104:107], v[12:15], v[60:63], v[104:107]
    v_mfma_f32_16x16x32_bf16 v[108:111], v[12:15], v[76:79], v[108:111]
    v_mfma_f32_16x16x32_bf16 v[112:115], v[12:15], v[96:99], v[112:115]
    s_nop 4
    ds_write_b32 v164, v100
    ds_write_b32 v165, v101
    ds_write_b32 v166, v102
    ds_write_b32 v167, v103
    ds_write_b32 v168, v104
    ds_write_b32 v169, v105
    ds_write_b32 v170, v106
    ds_write_b32 v171, v107
    ds_write_b32 v172, v108
    ds_write_b32 v173, v109
    ds_write_b32 v174, v110
    ds_write_b32 v175, v111
    s_nop 3
    ds_write_b32 v176, v112
    ds_write_b32 v177, v113
    ds_write_b32 v178, v114
    ds_write_b32 v179, v115
    s_branch L_k1_kv_out
L_k1_kvj_3:
    ds_read_b128 v[96:99], v160 offset:40960
    ds_read_b128 v[0:3], v160 offset:10240
    ds_read_b128 v[32:35], v160 offset:14336
    ds_read_b128 v[48:51], v160 offset:16384
    ds_read_b128 v[64:67], v160 offset:18432
    ds_read_b128 v[4:7], v160 offset:11264
    ds_read_b128 v[36:39], v160 offset:15360
    ds_read_b128 v[52:55], v160 offset:17408
    ds_read_b128 v[68:71], v160 offset:19456
    s_waitcnt lgkmcnt(4)
    ds_read_b128 v[8:11], v160 offset:30720
    ds_read_b128 v[40:43], v160 offset:34816
    ds_read_b128 v[56:59], v160 offset:36864
    ds_read_b128 v[72:75], v160 offset:38912
    v_mfma_f32_16x16x32_bf16 v[100:103], v[0:3], v[32:35], 0
    v_mfma_f32_16x16x32_bf16 v[104:107], v[0:3], v[48:51], 0
    v_mfma_f32_16x16x32_bf16 v[108:111], v[0:3], v[64:67], 0
    v_mfma_f32_16x16x32_bf16 v[112:115], v[0:3], v[96:99], 0
    s_waitcnt lgkmcnt(4)
    ds_read_b128 v[12:15], v160 offset:31744
    ds_read_b128 v[44:47], v160 offset:35840
    ds_read_b128 v[60:63], v160 offset:37888
    ds_read_b128 v[76:79], v160 offset:39936
    v_mfma_f32_16x16x32_bf16 v[100:103], v[4:7], v[36:39], v[100:103]
    v_mfma_f32_16x16x32_bf16 v[104:107], v[4:7], v[52:55], v[104:107]
    v_mfma_f32_16x16x32_bf16 v[108:111], v[4:7], v[68:71], v[108:111]
    v_mfma_f32_16x16x32_bf16 v[112:115], v[4:7], v[96:99], v[112:115]
    s_waitcnt lgkmcnt(4)
    v_mfma_f32_16x16x32_bf16 v[100:103], v[8:11], v[40:43], v[100:103]
    v_mfma_f32_16x16x32_bf16 v[104:107], v[8:11], v[56:59], v[104:107]
    v_mfma_f32_16x16x32_bf16 v[108:111], v[8:11], v[72:75], v[108:111]
    v_mfma_f32_16x16x32_bf16 v[112:115], v[8:11], v[96:99], v[112:115]
    s_waitcnt lgkmcnt(0)
    v_mfma_f32_16x16x32_bf16 v[100:103], v[12:15], v[44:47], v[100:103]
    v_mfma_f32_16x16x32_bf16 v[104:107], v[12:15], v[60:63], v[104:107]
    v_mfma_f32_16x16x32_bf16 v[108:111], v[12:15], v[76:79], v[108:111]
    v_mfma_f32_16x16x32_bf16 v[112:115], v[12:15], v[96:99], v[112:115]
    s_nop 4
    ds_write_b32 v164, v100
    ds_write_b32 v165, v101
    ds_write_b32 v166, v102
    ds_write_b32 v167, v103
    ds_write_b32 v168, v104
    ds_write_b32 v169, v105
    ds_write_b32 v170, v106
    ds_write_b32 v171, v107
    ds_write_b32 v172, v108
    ds_write_b32 v173, v109
    ds_write_b32 v174, v110
    ds_write_b32 v175, v111
    s_nop 3
    ds_write_b32 v176, v112
    ds_write_b32 v177, v113
    ds_write_b32 v178, v114
    ds_write_b32 v179, v115
L_k1_kv_out:
    s_waitcnt lgkmcnt(0)
    s_add_u32 s98, s98, 1
    s_lshl_b32 s99, s22, 2
    s_add_u32 s99, s99, 163712
    v_mov_b32 v212, s99
    v_mov_b32 v213, s98
    s_waitcnt lgkmcnt(0)
    ds_write_b32 v212, v213
    v_mov_b32 v212, 163712
L_csync_14:
    ds_read_b128 v[208:211], v212
    s_waitcnt lgkmcnt(0)
    v_min_u32 v208, v208, v209
    v_min_u32 v210, v210, v211
    v_min_u32 v208, v208, v210
    v_cmp_le_u32 vcc, v213, v208
    s_nop 0
    s_cbranch_vccz L_csync_14
    ds_read_b128 v[0:3], v207
    ds_read_b128 v[4:7], v207 offset:1024
    ds_read_b128 v[8:11], v160 offset:49664
    s_waitcnt lgkmcnt(2)
    buffer_store_dwordx4 v[0:3], v204, s[32:35], 0 offen sc1
    s_waitcnt lgkmcnt(1)
    buffer_store_dwordx4 v[4:7], v205, s[32:35], 0 offen sc1
    s_cmp_eq_u32 s22, 0
    s_cbranch_scc0 L_k1_kv_noz
    s_waitcnt lgkmcnt(0)
    buffer_store_dwordx4 v[8:11], v206, s[32:35], 0 offen sc1
L_k1_kv_noz:
    s_waitcnt vmcnt(0)
    s_add_u32 s98, s98, 1
    s_lshl_b32 s99, s22, 2
    s_add_u32 s99, s99, 163712
    v_mov_b32 v212, s99
    v_mov_b32 v213, s98
    s_waitcnt lgkmcnt(0)
    ds_write_b32 v212, v213
    v_mov_b32 v212, 163712
L_csync_16:
    ds_read_b128 v[208:211], v212
    s_waitcnt lgkmcnt(0)
    v_min_u32 v208, v208, v209
    v_min_u32 v210, v210, v211
    v_min_u32 v208, v208, v210
    v_cmp_le_u32 vcc, v213, v208
    s_nop 0
    s_cbranch_vccz L_csync_16
    s_cmp_eq_u32 s22, 0
    s_cbranch_scc0 L_dc_15
    s_mov_b32 s92, s96
    s_mov_b32 s93, s97
    s_mov_b32 s94, 256
    s_mov_b32 s95, 0x20000
    s_and_b32 s99, s2, 1
    s_lshl_b32 s99, s99, 7
    v_mov_b32 v208, s99
    v_mov_b32 v209, 1
    s_mov_b64 exec, 1
    buffer_atomic_add v209, v208, s[92:95], 0 offen sc0 sc1
    s_waitcnt vmcnt(0)
    v_readfirstlane_b32 s99, v209
    s_mov_b64 exec, -1
    s_and_b32 s99, s99, 127
    s_cmp_eq_u32 s99, 127
    s_cbranch_scc0 L_arr_17
    s_add_u32 s92, s12, 23379968
    s_addc_u32 s93, s13, 0
    s_mov_b32 s94, 40960
    s_mov_b32 s95, 0x20000
    s_and_b32 s99, s2, 1
    s_lshl_b32 s99, s99, 2
    s_add_u32 s99, s99, 8192
    v_and_b32 v208, 63, v254
    v_lshlrev_b32 v208, 7, v208
    v_add_u32 v208, s99, v208
    v_mov_b32 v209, 1
    buffer_store_dword v209, v208, s[92:95], 0 offen sc1
    v_add_u32 v208, 0x2000, v208
    buffer_store_dword v209, v208, s[92:95], 0 offen sc1
    v_add_u32 v208, 0x2000, v208
    buffer_store_dword v209, v208, s[92:95], 0 offen sc1
    v_add_u32 v208, 0x2000, v208
    buffer_store_dword v209, v208, s[92:95], 0 offen sc1
L_arr_17:
    v_mov_b32 v208, 163732
    v_mov_b32 v209, 1
    ds_write_b32 v208, v209
L_dc_15:
    s_branch L_phase2
L_k1_end:
    s_endpgm
L_phase2:
    v_mov_b32 v0, v254
    s_load_dwordx2 s[4:5], s[0:1], 40
    s_load_dwordx2 s[6:7], s[0:1], 0
    s_load_dwordx2 s[8:9], s[0:1], 16
    s_load_dwordx2 s[12:13], s[0:1], 88
    v_lshrrev_b32 v1, 6, v0
    v_and_b32 v0, 63, v0
    s_and_b32 s16, s2, 7
    s_lshr_b32 s17, s2, 3
    v_readfirstlane_b32 s22, v1
    s_cmp_ge_u32 s17, 28
    s_cbranch_scc1 L_k2_side
    s_mul_i32 s19, s16, 28
    s_add_u32 s19, s19, s17
    s_cmp_ge_u32 s19, 220
    s_cbranch_scc1 L_k2_idle
    s_mul_i32 s20, s19, 6554
    s_lshr_b32 s20, s20, 16
    s_mul_i32 s21, s20, 10
    s_sub_u32 s21, s19, s21
    s_cmp_lt_u32 s22, 4
    s_cbranch_scc1 L_k2_compute
    s_mul_i32 s49, s20, 21846
    s_lshr_b32 s49, s49, 16
    s_mul_i32 s49, s49, 3
    s_sub_u32 s49, s20, s49
    s_mul_i32 s49, s49, 3
    s_add_u32 s49, s49, s21
    s_cmp_ge_u32 s49, 10
    s_cselect_b32 s44, 10, 0
    s_sub_u32 s49, s49, s44
    s_setprio 0
    s_sub_u32 s22, s22, 4
    s_mul_i32 s36, s20, 96
    s_lshl_b32 s37, s22, 16
    v_add_u32 v2, s36, v0
    v_mov_b32 v5, s37
    v_cmp_gt_u32 vcc, 32, v0
    v_add_u32 v20, 64, v0
    v_subrev_u32 v21, 32, v0
    v_cndmask_b32 v20, v21, v20, vcc
    v_add_u32 v3, s36, v20
    v_mov_b32 v20, s37
    v_add_u32 v21, 32768, v20
    v_cndmask_b32 v6, v21, v20, vcc
    v_add_u32 v20, 32, v0
    v_add_u32 v4, s36, v20
    v_mov_b32 v7, v21
    v_lshrrev_b32 v20, 3, v0
    s_lshl_b32 s37, s22, 4
    v_add_u32 v20, s37, v20
    v_mul_u32_u24 v20, 1280, v20
    s_lshl_b32 s37, s21, 7
    v_add_u32 v20, s37, v20
    v_bfe_u32 v21, v0, 4, 1
    v_lshlrev_b32 v21, 1, v21
    v_and_b32 v22, 7, v0
    v_xor_b32 v21, v21, v22
    v_lshl_add_u32 v11, v21, 4, v20
    v_xor_b32 v21, 4, v21
    v_lshl_add_u32 v12, v21, 4, v20
    v_add_u32 v12, 10240, v12
    s_mul_i32 s41, s49, 1
    s_lshl_b32 s36, s41, 18
    s_mul_i32 s37, s41, 81920
    s_mul_i32 s42, s22, 3072
    s_lshl_b32 s43, s22, 11
    s_add_u32 s43, s43, 61440
    s_mov_b32 s40, s42
    s_mov_b32 s60, s43
    s_add_u32 s62, s42, 61440
    s_add_u32 s63, s43, 81920
    v_subrev_u32 v12, 0x400, v12
    v_add_u32 v5, 4096, v5
    v_add_u32 v6, 3072, v6
    v_add_u32 v7, 2048, v7
    v_subrev_u32 v20, 1, v2
    v_cmp_gt_u32 vcc, 0x800, v20
    v_lshl_add_u32 v20, v20, 4, v5
    v_mov_b32 v21, 0x80000000
    v_cndmask_b32 v40, v21, v20, vcc
    v_subrev_u32 v20, 1, v3
    v_cmp_gt_u32 vcc, 0x800, v20
    v_lshl_add_u32 v20, v20, 4, v6
    v_mov_b32 v21, 0x80000000
    v_cndmask_b32 v41, v21, v20, vcc
    v_subrev_u32 v20, 1, v4
    v_cmp_gt_u32 vcc, 0x800, v20
    v_lshl_add_u32 v20, v20, 4, v7
    v_mov_b32 v21, 0x80000000
    v_cndmask_b32 v42, v21, v20, vcc
    v_subrev_u32 v20, -1, v2
    v_cmp_gt_u32 vcc, 0x800, v20
    v_lshl_add_u32 v20, v20, 4, v5
    v_mov_b32 v21, 0x80000000
    v_cndmask_b32 v43, v21, v20, vcc
    v_subrev_u32 v20, -1, v3
    v_cmp_gt_u32 vcc, 0x800, v20
    v_lshl_add_u32 v20, v20, 4, v6
    v_mov_b32 v21, 0x80000000
    v_cndmask_b32 v44, v21, v20, vcc
    v_subrev_u32 v20, -1, v4
    v_cmp_gt_u32 vcc, 0x800, v20
    v_lshl_add_u32 v20, v20, 4, v7
    v_mov_b32 v21, 0x80000000
    v_cndmask_b32 v45, v21, v20, vcc
    v_subrev_u32 v20, 2, v2
    v_cmp_gt_u32 vcc, 0x800, v20
    v_lshl_add_u32 v20, v20, 4, v5
    v_mov_b32 v21, 0x80000000
    v_cndmask_b32 v46, v21, v20, vcc
    v_subrev_u32 v20, 2, v3
    v_cmp_gt_u32 vcc, 0x800, v20
    v_lshl_add_u32 v20, v20, 4, v6
    v_mov_b32 v21, 0x80000000
    v_cndmask_b32 v47, v21, v20, vcc
    v_subrev_u32 v20, 2, v4
    v_cmp_gt_u32 vcc, 0x800, v20
    v_lshl_add_u32 v20, v20, 4, v7
    v_mov_b32 v21, 0x80000000
    v_cndmask_b32 v48, v21, v20, vcc
    v_subrev_u32 v20, -2, v2
    v_cmp_gt_u32 vcc, 0x800, v20
    v_lshl_add_u32 v20, v20, 4, v5
    v_mov_b32 v21, 0x80000000
    v_cndmask_b32 v49, v21, v20, vcc
    v_subrev_u32 v20, -2, v3
    v_cmp_gt_u32 vcc, 0x800, v20
    v_lshl_add_u32 v20, v20, 4, v6
    v_mov_b32 v21, 0x80000000
    v_cndmask_b32 v50, v21, v20, vcc
    v_subrev_u32 v20, -2, v4
    v_cmp_gt_u32 vcc, 0x800, v20
    v_lshl_add_u32 v20, v20, 4, v7
    v_mov_b32 v21, 0x80000000
    v_cndmask_b32 v51, v21, v20, vcc
    s_lshl_b32 s61, s22, 1
    v_mov_b32 v8, v40
    v_mov_b32 v9, v41
    v_mov_b32 v10, v42
    s_lshl_b32 s44, s41, 3
    s_add_u32 s44, s44, s61
    s_mul_i32 s44, s44, 3277
    s_lshr_b32 s44, s44, 16
    s_mul_i32 s44, s44, 3
    s_set_gpr_idx_on s44, 0x1
    s_nop 0
    v_mov_b32 v8, v40
    v_mov_b32 v9, v41
    v_mov_b32 v10, v42
    s_set_gpr_idx_off
    s_waitcnt lgkmcnt(0)
    s_mov_b32 s32, s12
    s_mov_b32 s33, s13
    s_mov_b32 s34, 23379968
    s_mov_b32 s35, 0x20000
    s_add_u32 s24, s12, 2617344
    s_addc_u32 s25, s13, 0
    s_mov_b32 s26, 2625536
    s_mov_b32 s27, 0x20000
    s_mov_b32 s28, s4
    s_mov_b32 s29, s5
    s_mov_b32 s30, 819200
    s_mov_b32 s31, 0x20000
    s_mov_b32 s48, s6
    s_mov_b32 s49, s7
    s_mov_b32 s50, 2621440
    s_mov_b32 s51, 0x20000
    v_mov_b32 v30, 163732
L_own_18:
    ds_read_b32 v31, v30
    s_waitcnt lgkmcnt(0)
    v_cmp_le_u32 vcc, 1, v31
    s_nop 0
    s_cbranch_vccnz L_ownd_19
    s_branch L_own_18
L_ownd_19:
    s_mov_b32 s46, 0
L_k2_preB:
    s_mov_b32 m0, s60
    s_add_u32 s60, s60, 8192
    buffer_load_dwordx4 v11, s[28:31], s37 offen lds
    buffer_load_dwordx4 v12, s[28:31], s37 offen offset:1024 lds
    s_cmp_eq_u32 s60, s63
    s_cselect_b32 s60, s43, s60
    s_add_u32 s37, s37, 81920
    s_cmp_eq_u32 s37, 819200
    s_cselect_b32 s37, 0, s37
    s_add_u32 s46, s46, 1
    s_cmp_lt_u32 s46, 10
    s_cbranch_scc1 L_k2_preB
    s_cmp_eq_u32 s22, 0
    s_cbranch_scc0 L_dw_20
    v_mov_b32 v30, 163732
L_own_22:
    ds_read_b32 v31, v30
    s_waitcnt lgkmcnt(0)
    v_cmp_le_u32 vcc, 1, v31
    s_nop 0
    s_cbranch_vccnz L_ownd_23
    s_branch L_own_22
L_ownd_23:
    s_add_u32 s92, s12, 23379968
    s_addc_u32 s93, s13, 0
    s_mov_b32 s94, 40960
    s_mov_b32 s95, 0x20000
    s_lshl_b32 s99, s2, 7
    s_add_u32 s99, s99, 8192
    v_and_b32 v30, 1, v254
    v_lshlrev_b32 v30, 2, v30
    v_add_u32 v30, s99, v30
    v_mov_b32 v32, 1
    s_mov_b64 exec, 3
    s_mov_b32 s99, 0
L_pl_24:
    buffer_load_dword v31, v30, s[92:95], 0 offen sc1
    s_waitcnt vmcnt(0)
    v_cmp_ge_u32 vcc, v31, v32
    s_add_u32 s99, s99, 1
    s_nop 0
    s_cmp_eq_u64 vcc, exec
    s_cbranch_scc1 L_pld_25
    s_cmp_lt_u32 s99, 262144
    s_cbranch_scc1 L_pl_24
L_pld_25:
    s_mov_b64 exec, -1
    v_mov_b32 v30, 163728
    v_mov_b32 v31, 1
    ds_write_b32 v30, v31
    s_branch L_dwd_21
L_dw_20:
    v_mov_b32 v30, 163728
L_dep_26:
    ds_read_b32 v31, v30
    s_waitcnt lgkmcnt(0)
    v_cmp_le_u32 vcc, 1, v31
    s_nop 0
    s_cbranch_vccnz L_depd_27
    s_branch L_dep_26
L_depd_27:
L_dwd_21:
    s_mov_b32 s46, 0
L_k2_preA:
    s_mov_b32 m0, s40
    s_add_u32 s40, s40, 12288
    buffer_load_dwordx4 v8, s[24:27], s36 offen offset:0 sc1 lds
    buffer_load_dwordx4 v9, s[24:27], s36 offen offset:1024 sc1 lds
    buffer_load_dwordx4 v10, s[24:27], s36 offen offset:2048 sc1 lds
    s_cmp_eq_u32 s40, s62
    s_cselect_b32 s40, s42, s40
    s_add_u32 s36, s36, 262144
    s_cmp_eq_u32 s36, 2621440
    s_cselect_b32 s36, 0, s36
    s_add_u32 s41, s41, 1
    s_cmp_eq_u32 s41, 10
    s_cselect_b32 s41, 0, s41
    s_lshl_b32 s44, s41, 3
    s_add_u32 s44, s44, s61
    s_mul_i32 s44, s44, 3277
    s_lshr_b32 s44, s44, 16
    s_mul_i32 s44, s44, 3
    s_set_gpr_idx_on s44, 0x1
    s_nop 0
    v_mov_b32 v8, v40
    v_mov_b32 v9, v41
    v_mov_b32 v10, v42
    s_set_gpr_idx_off
    s_add_u32 s46, s46, 1
    s_cmp_lt_u32 s46, 3
    s_cbranch_scc1 L_k2_preA
    s_mov_b32 s46, 0
L_k2_seg0:
    s_waitcnt vmcnt(6)
    s_barrier
    s_mov_b32 m0, s40
    s_add_u32 s40, s40, 12288
    buffer_load_dwordx4 v8, s[24:27], s36 offen offset:0 sc1 lds
    buffer_load_dwordx4 v9, s[24:27], s36 offen offset:1024 sc1 lds
    buffer_load_dwordx4 v10, s[24:27], s36 offen offset:2048 sc1 lds
    s_cmp_eq_u32 s40, s62
    s_cselect_b32 s40, s42, s40
    s_add_u32 s36, s36, 262144
    s_cmp_eq_u32 s36, 2621440
    s_cselect_b32 s36, 0, s36
    s_add_u32 s41, s41, 1
    s_cmp_eq_u32 s41, 10
    s_cselect_b32 s41, 0, s41
    s_lshl_b32 s44, s41, 3
    s_add_u32 s44, s44, s61
    s_mul_i32 s44, s44, 3277
    s_lshr_b32 s44, s44, 16
    s_mul_i32 s44, s44, 3
    s_set_gpr_idx_on s44, 0x1
    s_nop 0
    v_mov_b32 v8, v40
    v_mov_b32 v9, v41
    v_mov_b32 v10, v42
    s_set_gpr_idx_off
    s_add_u32 s46, s46, 1
    s_cmp_lt_u32 s46, 7
    s_cbranch_scc1 L_k2_seg0
    s_waitcnt vmcnt(6)
    s_barrier
    v_lshrrev_b32 v20, 3, v0
    s_mul_i32 s44, s20, 96
    s_mul_i32 s45, s22, 24
    s_add_u32 s44, s44, s45
    v_add_u32 v20, s44, v20
    v_mul_u32_u24 v20, 1280, v20
    s_lshl_b32 s44, s21, 7
    v_add_u32 v20, s44, v20
    s_mul_i32 s44, s22, 3072
    s_add_u32 s44, s44, 61440
    s_mul_i32 s45, s22, 12
    s_add_u32 s45, s45, 0
    v_lshrrev_b32 v21, 4, v0
    v_add_u32 v21, s45, v21
    v_and_b32 v21, 7, v21
    v_and_b32 v22, 7, v0
    v_xor_b32 v21, v21, v22
    v_lshl_add_u32 v23, v21, 4, v20
    v_add_u32 v23, 0, v23
    s_add_u32 m0, s44, 0
    s_nop 0
    buffer_load_dwordx4 v23, s[48:51], 0 offen lds
    s_mul_i32 s45, s22, 12
    s_add_u32 s45, s45, 4
    v_lshrrev_b32 v21, 4, v0
    v_add_u32 v21, s45, v21
    v_and_b32 v21, 7, v21
    v_and_b32 v22, 7, v0
    v_xor_b32 v21, v21, v22
    v_lshl_add_u32 v24, v21, 4, v20
    v_add_u32 v24, 10240, v24
    s_add_u32 m0, s44, 1024
    s_nop 0
    buffer_load_dwordx4 v24, s[48:51], 0 offen lds
    s_mul_i32 s45, s22, 12
    s_add_u32 s45, s45, 8
    v_lshrrev_b32 v21, 4, v0
    v_add_u32 v21, s45, v21
    v_and_b32 v21, 7, v21
    v_and_b32 v22, 7, v0
    v_xor_b32 v21, v21, v22
    v_lshl_add_u32 v25, v21, 4, v20
    v_add_u32 v25, 20480, v25
    s_add_u32 m0, s44, 2048
    s_nop 0
    buffer_load_dwordx4 v25, s[48:51], 0 offen lds
    s_waitcnt vmcnt(6)
    s_barrier
    s_waitcnt vmcnt(3)
    s_barrier
    s_waitcnt vmcnt(0)
    s_barrier
    s_branch L_phase3
L_k2_compute:
    s_setprio 0
    v_mov_b32 v107, v0
    s_lshr_b32 s36, s22, 1
    s_and_b32 s37, s22, 1
    v_and_b32 v110, 15, v0
    v_lshrrev_b32 v111, 4, v0
    v_mul_u32_u24 v112, 1536, v111
    v_lshl_add_u32 v112, v110, 4, v112
    s_mul_i32 s38, s36, 768
    v_add_u32 v104, s38, v112
    v_lshrrev_b32 v112, 2, v110
    v_lshlrev_b32 v113, 3, v111
    v_add_u32 v113, v113, v112
    v_lshlrev_b32 v113, 7, v113
    v_and_b32 v114, 3, v110
    v_lshl_add_u32 v113, v114, 3, v113
    v_add_u32 v113, 61440, v113
    v_lshrrev_b32 v112, 1, v112
    v_and_b32 v114, 1, v111
    v_lshlrev_b32 v114, 1, v114
    s_lshl_b32 s38, s37, 1
    v_xor_b32 v114, s38, v114
    v_add_u32 v115, v114, v112
    v_lshl_add_u32 v105, v115, 5, v113
    v_xor_b32 v112, 1, v112
    v_add_u32 v115, v114, v112
    v_lshl_add_u32 v106, v115, 5, v113
    v_mov_b32 v0, 0
    v_mov_b32 v1, 0
    v_mov_b32 v2, 0
    v_mov_b32 v3, 0
    v_mov_b32 v4, 0
    v_mov_b32 v5, 0
    v_mov_b32 v6, 0
    v_mov_b32 v7, 0
    v_mov_b32 v8, 0
    v_mov_b32 v9, 0
    v_mov_b32 v10, 0
    v_mov_b32 v11, 0
    v_mov_b32 v12, 0
    v_mov_b32 v13, 0
    v_mov_b32 v14, 0
    v_mov_b32 v15, 0
    v_mov_b32 v16, 0
    v_mov_b32 v17, 0
    v_mov_b32 v18, 0
    v_mov_b32 v19, 0
    v_mov_b32 v20, 0
    v_mov_b32 v21, 0
    v_mov_b32 v22, 0
    v_mov_b32 v23, 0
    v_and_b32 v110, 15, v107
    v_lshrrev_b32 v111, 4, v107
    s_mul_i32 s38, s36, 48
    v_add_u32 v112, s38, v110
    v_lshrrev_b32 v113, 1, v112
    v_and_b32 v113, 7, v113
    v_lshrrev_b32 v114, 1, v111
    s_lshl_b32 s38, s37, 2
    v_add_u32 v114, s38, v114
    v_xor_b32 v114, v114, v113
    v_lshlrev_b32 v114, 4, v114
    v_and_b32 v115, 1, v111
    v_lshl_add_u32 v114, v115, 3, v114
    v_lshl_add_u32 v114, v112, 7, v114
    v_add_u32 v144, 61440, v114
    v_xor_b32 v145, 32, v144
    v_lshlrev_b32 v147, 3, v110
    s_mul_i32 s38, s22, 384
    v_add_u32 v147, s38, v147
    s_mul_i32 s38, s20, 96
    s_mul_i32 s39, s36, 48
    s_add_u32 s38, s38, s39
    v_add_u32 v112, s38, v110
    s_lshl_b32 s38, s21, 14
    s_add_u32 s38, s38, 21905408
    v_lshl_add_u32 v146, v112, 3, s38
    v_mov_b32 v148, 0x3f803f80
    s_mov_b32 s44, 5242880
    v_lshrrev_b32 v117, 4, v107
    v_and_b32 v116, 15, v107
    v_and_b32 v118, 1, v117
    v_lshrrev_b32 v119, 1, v117
    v_lshl_add_u32 v119, v118, 1, v119
    s_lshl_b32 s38, s21, 3
    s_lshl_b32 s39, s37, 2
    s_add_u32 s38, s38, s39
    v_add_u32 v119, s38, v119
    v_lshlrev_b32 v119, 15, v119
    v_add_u32 v119, s44, v119
    s_mul_i32 s38, s20, 96
    s_mul_i32 s39, s36, 48
    s_add_u32 s38, s38, s39
    v_add_u32 v116, s38, v116
    v_add_u32 v120, 0, v116
    v_cmp_gt_u32 vcc, 0x800, v120
    v_lshl_add_u32 v120, v120, 4, v119
    v_mov_b32 v121, 0x80000000
    v_cndmask_b32 v140, v121, v120, vcc
    v_add_u32 v120, 16, v116
    v_cmp_gt_u32 vcc, 0x800, v120
    v_lshl_add_u32 v120, v120, 4, v119
    v_mov_b32 v121, 0x80000000
    v_cndmask_b32 v141, v121, v120, vcc
    v_add_u32 v120, 32, v116
    v_cmp_gt_u32 vcc, 0x800, v120
    v_lshl_add_u32 v120, v120, 4, v119
    v_mov_b32 v121, 0x80000000
    v_cndmask_b32 v142, v121, v120, vcc
    s_waitcnt lgkmcnt(0)
    s_mov_b32 s32, s12
    s_mov_b32 s33, s13
    s_mov_b32 s34, 23379968
    s_mov_b32 s35, 0x20000
    v_mov_b32 v108, v104
    v_mov_b32 v109, v105
    v_mov_b32 v116, v106
    s_mov_b32 s40, 0
    s_mov_b32 s41, 0
    s_mov_b32 s43, 0
    s_barrier
    ds_read_b64_tr_b16 v[48:49], v105 offset:0
    ds_read_b64_tr_b16 v[50:51], v105 offset:512
    ds_read_b128 v[24:27], v104 offset:0
    ds_read_b64_tr_b16 v[52:53], v106 offset:0
    ds_read_b64_tr_b16 v[54:55], v106 offset:512
    ds_read_b128 v[28:31], v104 offset:256
    ds_read_b128 v[32:35], v104 offset:512
    ds_read_b64_tr_b16 v[56:57], v105 offset:4096
    ds_read_b64_tr_b16 v[58:59], v105 offset:4608
    ds_read_b128 v[36:39], v104 offset:6144
    ds_read_b64_tr_b16 v[60:61], v106 offset:4096
    ds_read_b64_tr_b16 v[62:63], v106 offset:4608
    ds_read_b128 v[40:43], v104 offset:6400
    ds_read_b128 v[44:47], v104 offset:6656
    s_add_u32 s40, s40, 1
    s_add_u32 s41, s41, 12288
    s_cmp_eq_u32 s41, 61440
    s_cselect_b32 s41, 0, s41
    s_add_u32 s43, s43, 8192
    s_cmp_eq_u32 s43, 81920
    s_cselect_b32 s43, 0, s43
    v_add_u32 v104, s41, v108
    v_add_u32 v105, s43, v109
    v_add_u32 v106, s43, v116
    s_cmp_eq_u32 s40, 10
L_k2_main:
    s_cbranch_scc1 L_k2_last0
    s_barrier
    s_waitcnt lgkmcnt(0)
    ds_read_b64_tr_b16 v[88:89], v105 offset:0
    ds_read_b64_tr_b16 v[90:91], v105 offset:512
    v_mfma_f32_16x16x32_bf16 v[0:3], v[48:51], v[24:27], v[0:3]
    ds_read_b128 v[64:67], v104 offset:0
    ds_read_b64_tr_b16 v[92:93], v106 offset:0
    v_mfma_f32_16x16x32_bf16 v[4:7], v[52:55], v[24:27], v[4:7]
    ds_read_b64_tr_b16 v[94:95], v106 offset:512
    ds_read_b128 v[68:71], v104 offset:256
    v_mfma_f32_16x16x32_bf16 v[8:11], v[48:51], v[28:31], v[8:11]
    ds_read_b128 v[72:75], v104 offset:512
    ds_read_b64_tr_b16 v[96:97], v105 offset:4096
    v_mfma_f32_16x16x32_bf16 v[12:15], v[52:55], v[28:31], v[12:15]
    ds_read_b64_tr_b16 v[98:99], v105 offset:4608
    ds_read_b128 v[76:79], v104 offset:6144
    v_mfma_f32_16x16x32_bf16 v[16:19], v[48:51], v[32:35], v[16:19]
    ds_read_b64_tr_b16 v[100:101], v106 offset:4096
    ds_read_b64_tr_b16 v[102:103], v106 offset:4608
    v_mfma_f32_16x16x32_bf16 v[20:23], v[52:55], v[32:35], v[20:23]
    ds_read_b128 v[80:83], v104 offset:6400
    ds_read_b128 v[84:87], v104 offset:6656
    v_mfma_f32_16x16x32_bf16 v[0:3], v[56:59], v[36:39], v[0:3]
    s_add_u32 s40, s40, 1
    s_add_u32 s41, s41, 12288
    s_cmp_eq_u32 s41, 61440
    v_mfma_f32_16x16x32_bf16 v[4:7], v[60:63], v[36:39], v[4:7]
    s_cselect_b32 s41, 0, s41
    s_add_u32 s43, s43, 8192
    s_cmp_eq_u32 s43, 81920
    v_mfma_f32_16x16x32_bf16 v[8:11], v[56:59], v[40:43], v[8:11]
    s_cselect_b32 s43, 0, s43
    v_add_u32 v104, s41, v108
    v_add_u32 v105, s43, v109
    v_mfma_f32_16x16x32_bf16 v[12:15], v[60:63], v[40:43], v[12:15]
    v_add_u32 v106, s43, v116
    s_cmp_eq_u32 s40, 10
    v_mfma_f32_16x16x32_bf16 v[16:19], v[56:59], v[44:47], v[16:19]
    v_mfma_f32_16x16x32_bf16 v[20:23], v[60:63], v[44:47], v[20:23]
    s_cbranch_scc1 L_k2_last1
    s_barrier
    s_waitcnt lgkmcnt(0)
    ds_read_b64_tr_b16 v[48:49], v105 offset:0
    ds_read_b64_tr_b16 v[50:51], v105 offset:512
    v_mfma_f32_16x16x32_bf16 v[0:3], v[88:91], v[64:67], v[0:3]
    ds_read_b128 v[24:27], v104 offset:0
    ds_read_b64_tr_b16 v[52:53], v106 offset:0
    v_mfma_f32_16x16x32_bf16 v[4:7], v[92:95], v[64:67], v[4:7]
    ds_read_b64_tr_b16 v[54:55], v106 offset:512
    ds_read_b128 v[28:31], v104 offset:256
    v_mfma_f32_16x16x32_bf16 v[8:11], v[88:91], v[68:71], v[8:11]
    ds_read_b128 v[32:35], v104 offset:512
    ds_read_b64_tr_b16 v[56:57], v105 offset:4096
    v_mfma_f32_16x16x32_bf16 v[12:15], v[92:95], v[68:71], v[12:15]
    ds_read_b64_tr_b16 v[58:59], v105 offset:4608
    ds_read_b128 v[36:39], v104 offset:6144
    v_mfma_f32_16x16x32_bf16 v[16:19], v[88:91], v[72:75], v[16:19]
    ds_read_b64_tr_b16 v[60:61], v106 offset:4096
    ds_read_b64_tr_b16 v[62:63], v106 offset:4608
    v_mfma_f32_16x16x32_bf16 v[20:23], v[92:95], v[72:75], v[20:23]
    ds_read_b128 v[40:43], v104 offset:6400
    ds_read_b128 v[44:47], v104 offset:6656
    v_mfma_f32_16x16x32_bf16 v[0:3], v[96:99], v[76:79], v[0:3]
    s_add_u32 s40, s40, 1
    s_add_u32 s41, s41, 12288
    s_cmp_eq_u32 s41, 61440
    v_mfma_f32_16x16x32_bf16 v[4:7], v[100:103], v[76:79], v[4:7]
    s_cselect_b32 s41, 0, s41
    s_add_u32 s43, s43, 8192
    s_cmp_eq_u32 s43, 81920
    v_mfma_f32_16x16x32_bf16 v[8:11], v[96:99], v[80:83], v[8:11]
    s_cselect_b32 s43, 0, s43
    v_add_u32 v104, s41, v108
    v_add_u32 v105, s43, v109
    v_mfma_f32_16x16x32_bf16 v[12:15], v[100:103], v[80:83], v[12:15]
    v_add_u32 v106, s43, v116
    s_cmp_eq_u32 s40, 10
    v_mfma_f32_16x16x32_bf16 v[16:19], v[96:99], v[84:87], v[16:19]
    v_mfma_f32_16x16x32_bf16 v[20:23], v[100:103], v[84:87], v[20:23]
    s_branch L_k2_main
L_k2_last0:
    s_waitcnt lgkmcnt(0)
    v_mfma_f32_16x16x32_bf16 v[0:3], v[48:51], v[24:27], v[0:3]
    v_mfma_f32_16x16x32_bf16 v[4:7], v[52:55], v[24:27], v[4:7]
    v_mfma_f32_16x16x32_bf16 v[8:11], v[48:51], v[28:31], v[8:11]
    v_mfma_f32_16x16x32_bf16 v[12:15], v[52:55], v[28:31], v[12:15]
    v_mfma_f32_16x16x32_bf16 v[16:19], v[48:51], v[32:35], v[16:19]
    v_mfma_f32_16x16x32_bf16 v[20:23], v[52:55], v[32:35], v[20:23]
    v_mfma_f32_16x16x32_bf16 v[0:3], v[56:59], v[36:39], v[0:3]
    v_mfma_f32_16x16x32_bf16 v[4:7], v[60:63], v[36:39], v[4:7]
    v_mfma_f32_16x16x32_bf16 v[8:11], v[56:59], v[40:43], v[8:11]
    v_mfma_f32_16x16x32_bf16 v[12:15], v[60:63], v[40:43], v[12:15]
    v_mfma_f32_16x16x32_bf16 v[16:19], v[56:59], v[44:47], v[16:19]
    v_mfma_f32_16x16x32_bf16 v[20:23], v[60:63], v[44:47], v[20:23]
    s_branch L_k2_done
L_k2_last1:
    s_waitcnt lgkmcnt(0)
    v_mfma_f32_16x16x32_bf16 v[0:3], v[88:91], v[64:67], v[0:3]
    v_mfma_f32_16x16x32_bf16 v[4:7], v[92:95], v[64:67], v[4:7]
    v_mfma_f32_16x16x32_bf16 v[8:11], v[88:91], v[68:71], v[8:11]
    v_mfma_f32_16x16x32_bf16 v[12:15], v[92:95], v[68:71], v[12:15]
    v_mfma_f32_16x16x32_bf16 v[16:19], v[88:91], v[72:75], v[16:19]
    v_mfma_f32_16x16x32_bf16 v[20:23], v[92:95], v[72:75], v[20:23]
    v_mfma_f32_16x16x32_bf16 v[0:3], v[96:99], v[76:79], v[0:3]
    v_mfma_f32_16x16x32_bf16 v[4:7], v[100:103], v[76:79], v[4:7]
    v_mfma_f32_16x16x32_bf16 v[8:11], v[96:99], v[80:83], v[8:11]
    v_mfma_f32_16x16x32_bf16 v[12:15], v[100:103], v[80:83], v[12:15]
    v_mfma_f32_16x16x32_bf16 v[16:19], v[96:99], v[84:87], v[16:19]
    v_mfma_f32_16x16x32_bf16 v[20:23], v[100:103], v[84:87], v[20:23]
L_k2_done:
    s_barrier
    ds_read_b64 v[24:25], v144 offset:0
    ds_read_b64 v[26:27], v145 offset:0
    ds_read_b64 v[28:29], v144 offset:2048
    ds_read_b64 v[30:31], v145 offset:2048
    ds_read_b64 v[32:33], v144 offset:4096
    ds_read_b64 v[34:35], v145 offset:4096
    v_mov_b32 v150, 0
    v_mov_b32 v151, 0
    v_mov_b32 v152, 0
    v_mov_b32 v153, 0
    v_mov_b32 v154, 0
    v_mov_b32 v155, 0
    s_waitcnt lgkmcnt(0)
    v_lshlrev_b32 v48, 16, v24
    v_and_b32 v49, 0xffff0000, v24
    v_lshlrev_b32 v50, 16, v25
    v_and_b32 v51, 0xffff0000, v25
    v_pk_add_f32 v[0:1], v[0:1], v[48:49]
    v_pk_add_f32 v[2:3], v[2:3], v[50:51]
    v_cvt_pk_bf16_f32 v40, v0, v1
    v_cvt_pk_bf16_f32 v41, v2, v3
    v_lshlrev_b32 v48, 16, v26
    v_and_b32 v49, 0xffff0000, v26
    v_lshlrev_b32 v50, 16, v27
    v_and_b32 v51, 0xffff0000, v27
    v_pk_add_f32 v[4:5], v[4:5], v[48:49]
    v_pk_add_f32 v[6:7], v[6:7], v[50:51]
    v_cvt_pk_bf16_f32 v42, v4, v5
    v_cvt_pk_bf16_f32 v43, v6, v7
    v_dot2_f32_bf16 v150, v40, v148, v150
    v_dot2_f32_bf16 v151, v40, v40, v151
    v_dot2_f32_bf16 v150, v41, v148, v150
    v_dot2_f32_bf16 v151, v41, v41, v151
    v_dot2_f32_bf16 v150, v42, v148, v150
    v_dot2_f32_bf16 v151, v42, v42, v151
    v_dot2_f32_bf16 v150, v43, v148, v150
    v_dot2_f32_bf16 v151, v43, v43, v151
    s_nop 1
    v_permlane16_swap_b32 v40, v42
    v_permlane16_swap_b32 v41, v43
    buffer_store_dwordx4 v[40:43], v140, s[32:35], 0 offen sc1
    v_lshlrev_b32 v48, 16, v28
    v_and_b32 v49, 0xffff0000, v28
    v_lshlrev_b32 v50, 16, v29
    v_and_b32 v51, 0xffff0000, v29
    v_pk_add_f32 v[8:9], v[8:9], v[48:49]
    v_pk_add_f32 v[10:11], v[10:11], v[50:51]
    v_cvt_pk_bf16_f32 v44, v8, v9
    v_cvt_pk_bf16_f32 v45, v10, v11
    v_lshlrev_b32 v48, 16, v30
    v_and_b32 v49, 0xffff0000, v30
    v_lshlrev_b32 v50, 16, v31
    v_and_b32 v51, 0xffff0000, v31
    v_pk_add_f32 v[12:13], v[12:13], v[48:49]
    v_pk_add_f32 v[14:15], v[14:15], v[50:51]
    v_cvt_pk_bf16_f32 v46, v12, v13
    v_cvt_pk_bf16_f32 v47, v14, v15
    v_dot2_f32_bf16 v152, v44, v148, v152
    v_dot2_f32_bf16 v153, v44, v44, v153
    v_dot2_f32_bf16 v152, v45, v148, v152
    v_dot2_f32_bf16 v153, v45, v45, v153
    v_dot2_f32_bf16 v152, v46, v148, v152
    v_dot2_f32_bf16 v153, v46, v46, v153
    v_dot2_f32_bf16 v152, v47, v148, v152
    v_dot2_f32_bf16 v153, v47, v47, v153
    s_nop 1
    v_permlane16_swap_b32 v44, v46
    v_permlane16_swap_b32 v45, v47
    buffer_store_dwordx4 v[44:47], v141, s[32:35], 0 offen sc1
    v_lshlrev_b32 v48, 16, v32
    v_and_b32 v49, 0xffff0000, v32
    v_lshlrev_b32 v50, 16, v33
    v_and_b32 v51, 0xffff0000, v33
    v_pk_add_f32 v[16:17], v[16:17], v[48:49]
    v_pk_add_f32 v[18:19], v[18:19], v[50:51]
    v_cvt_pk_bf16_f32 v40, v16, v17
    v_cvt_pk_bf16_f32 v41, v18, v19
    v_lshlrev_b32 v48, 16, v34
    v_and_b32 v49, 0xffff0000, v34
    v_lshlrev_b32 v50, 16, v35
    v_and_b32 v51, 0xffff0000, v35
    v_pk_add_f32 v[20:21], v[20:21], v[48:49]
    v_pk_add_f32 v[22:23], v[22:23], v[50:51]
    v_cvt_pk_bf16_f32 v42, v20, v21
    v_cvt_pk_bf16_f32 v43, v22, v23
    v_dot2_f32_bf16 v154, v40, v148, v154
    v_dot2_f32_bf16 v155, v40, v40, v155
    v_dot2_f32_bf16 v154, v41, v148, v154
    v_dot2_f32_bf16 v155, v41, v41, v155
    v_dot2_f32_bf16 v154, v42, v148, v154
    v_dot2_f32_bf16 v155, v42, v42, v155
    v_dot2_f32_bf16 v154, v43, v148, v154
    v_dot2_f32_bf16 v155, v43, v43, v155
    s_nop 1
    v_permlane16_swap_b32 v40, v42
    v_permlane16_swap_b32 v41, v43
    buffer_store_dwordx4 v[40:43], v142, s[32:35], 0 offen sc1
    s_nop 1
    v_mov_b32 v56, v150
    v_mov_b32 v57, v151
    v_mov_b32 v58, v152
    v_mov_b32 v59, v153
    v_mov_b32 v60, v154
    v_mov_b32 v61, v155
    s_nop 1
    v_permlane16_swap_b32 v56, v150
    v_permlane16_swap_b32 v57, v151
    v_permlane16_swap_b32 v58, v152
    v_permlane16_swap_b32 v59, v153
    v_permlane16_swap_b32 v60, v154
    v_permlane16_swap_b32 v61, v155
    s_nop 1
    v_add_f32 v150, v150, v56
    v_add_f32 v151, v151, v57
    v_add_f32 v152, v152, v58
    v_add_f32 v153, v153, v59
    v_add_f32 v154, v154, v60
    v_add_f32 v155, v155, v61
    s_nop 0
    v_mov_b32 v56, v150
    v_mov_b32 v57, v151
    v_mov_b32 v58, v152
    v_mov_b32 v59, v153
    v_mov_b32 v60, v154
    v_mov_b32 v61, v155
    s_nop 1
    v_permlane32_swap_b32 v56, v150
    v_permlane32_swap_b32 v57, v151
    v_permlane32_swap_b32 v58, v152
    v_permlane32_swap_b32 v59, v153
    v_permlane32_swap_b32 v60, v154
    v_permlane32_swap_b32 v61, v155
    s_nop 1
    v_add_f32 v150, v150, v56
    v_add_f32 v151, v151, v57
    v_add_f32 v152, v152, v58
    v_add_f32 v153, v153, v59
    v_add_f32 v154, v154, v60
    v_add_f32 v155, v155, v61
    s_nop 0
    ds_write_b64 v147, v[150:151] offset:0
    ds_write_b64 v147, v[152:153] offset:128
    ds_write_b64 v147, v[154:155] offset:256
    s_waitcnt lgkmcnt(0)
    s_add_u32 s98, s98, 1
    s_lshl_b32 s99, s22, 2
    s_add_u32 s99, s99, 163712
    v_mov_b32 v164, s99
    v_mov_b32 v165, s98
    s_waitcnt lgkmcnt(0)
    ds_write_b32 v164, v165
    v_mov_b32 v164, 163712
L_csync_28:
    ds_read_b128 v[160:163], v164
    s_waitcnt lgkmcnt(0)
    v_min_u32 v160, v160, v161
    v_min_u32 v162, v162, v163
    v_min_u32 v160, v160, v162
    v_cmp_le_u32 vcc, v165, v160
    s_nop 0
    s_cbranch_vccz L_csync_28
    s_cmp_eq_u32 s37, 1
    s_cbranch_scc1 L_k2_nostat
    ds_read_b64 v[56:57], v147 offset:384
    ds_read_b64 v[58:59], v147 offset:512
    ds_read_b64 v[60:61], v147 offset:640
    v_and_b32 v110, 15, v107
    s_mul_i32 s38, s20, 96
    s_mul_i32 s39, s36, 48
    s_add_u32 s38, s38, s39
    v_add_u32 v110, s38, v110
    v_cmp_gt_u32 s[50:51], 16, v107
    v_mov_b32 v112, 0x80000000
    s_waitcnt lgkmcnt(0)
    v_add_u32 v111, 0, v110
    v_cmp_gt_u32 vcc, 0x800, v111
    v_pk_add_f32 v[150:151], v[150:151], v[56:57]
    s_and_b64 vcc, vcc, s[50:51]
    v_add_u32 v111, 0, v146
    s_nop 0
    v_cndmask_b32 v111, v112, v111, vcc
    buffer_store_dwordx2 v[150:151], v111, s[32:35], 0 offen sc1
    v_add_u32 v111, 16, v110
    v_cmp_gt_u32 vcc, 0x800, v111
    v_pk_add_f32 v[152:153], v[152:153], v[58:59]
    s_and_b64 vcc, vcc, s[50:51]
    v_add_u32 v111, 128, v146
    s_nop 0
    v_cndmask_b32 v111, v112, v111, vcc
    buffer_store_dwordx2 v[152:153], v111, s[32:35], 0 offen sc1
    v_add_u32 v111, 32, v110
    v_cmp_gt_u32 vcc, 0x800, v111
    v_pk_add_f32 v[154:155], v[154:155], v[60:61]
    s_and_b64 vcc, vcc, s[50:51]
    v_add_u32 v111, 256, v146
    s_nop 0
    v_cndmask_b32 v111, v112, v111, vcc
    buffer_store_dwordx2 v[154:155], v111, s[32:35], 0 offen sc1
L_k2_nostat:
    s_add_u32 s44, s20, 0
    s_waitcnt vmcnt(0)
    s_add_u32 s98, s98, 1
    s_lshl_b32 s99, s22, 2
    s_add_u32 s99, s99, 163712
    v_mov_b32 v164, s99
    v_mov_b32 v165, s98
    s_waitcnt lgkmcnt(0)
    ds_write_b32 v164, v165
    v_mov_b32 v164, 163712
L_csync_30:
    ds_read_b128 v[160:163], v164
    s_waitcnt lgkmcnt(0)
    v_min_u32 v160, v160, v161
    v_min_u32 v162, v162, v163
    v_min_u32 v160, v160, v162
    v_cmp_le_u32 vcc, v165, v160
    s_nop 0
    s_cbranch_vccz L_csync_30
    s_cmp_eq_u32 s22, 0
    s_cbranch_scc0 L_dc_29
    s_add_u32 s92, s12, 23379968
    s_addc_u32 s93, s13, 0
    s_mov_b32 s94, 40960
    s_mov_b32 s95, 0x20000
    s_mov_b32 s99, s44
    s_lshl_b32 s99, s99, 7
    v_mov_b32 v160, s99
    v_mov_b32 v161, 1
    s_mov_b64 exec, 1
    buffer_atomic_add v161, v160, s[92:95], 0 offen sc1
    s_mov_b64 exec, -1
    v_mov_b32 v160, 163732
    v_mov_b32 v161, 2
    ds_write_b32 v160, v161
L_dc_29:
    s_branch L_phase3
L_k2_side:
    s_sub_u32 s20, s17, 28
    s_lshl_b32 s20, s20, 3
    s_add_u32 s20, s20, s16
    v_mov_b32 v124, 163732
L_own_31:
    ds_read_b32 v125, v124
    s_waitcnt lgkmcnt(0)
    v_cmp_le_u32 vcc, 1, v125
    s_nop 0
    s_cbranch_vccnz L_ownd_32
    s_branch L_own_31
L_ownd_32:
    s_and_b32 s21, s20, 7
    s_lshr_b32 s23, s20, 3
    s_lshl_b32 s36, s23, 9
    s_lshl_b32 s37, s22, 6
    s_add_u32 s36, s36, s37
    v_add_u32 v1, s36, v0
    v_lshlrev_b32 v1, 4, v1
    s_mul_i32 s37, s21, 327680
    v_add_u32 v1, s37, v1
    v_mov_b32 v173, 0x80000000
    v_lshlrev_b32 v164, 4, v0
    v_cmp_gt_u32 vcc, 20, v0
    v_add_u32 v165, 1024, v164
    v_cmp_gt_u32 s[40:41], 36, v0
    v_cndmask_b32 v166, v173, v164, vcc
    s_lshl_b32 s44, s22, 1
    s_mul_i32 s44, s44, 2560
    s_mul_i32 s39, s21, 320
    v_cndmask_b32 v165, v173, v165, s[40:41]
    s_add_u32 s44, s44, s39
    s_add_u32 s44, s44, 21856256
    s_add_u32 s45, s44, 2560
    s_lshl_b32 s46, s22, 6
    s_add_u32 s46, s46, s20
    s_mul_i32 s46, s46, 1664
    s_add_u32 s46, s46, 21004288
    s_add_u32 s47, s46, 53248
    v_mov_b32 v72, 0
    v_mov_b32 v73, 0
    v_mov_b32 v74, 0
    v_mov_b32 v75, 0
    ds_write_b128 v164, v[72:75] offset:20480
    ds_write_b128 v164, v[72:75] offset:21504
    s_waitcnt lgkmcnt(0)
    s_mov_b32 s32, s12
    s_mov_b32 s33, s13
    s_mov_b32 s34, 23379968
    s_mov_b32 s35, 0x20000
    s_mov_b32 s28, s8
    s_mov_b32 s29, s9
    s_mov_b32 s30, 819200
    s_mov_b32 s31, 0x20000
    s_cmp_ge_u32 s22, 5
    s_cbranch_scc1 L_k2_s_nowo
    v_lshrrev_b32 v169, 4, v0
    s_mul_i32 s38, s20, 20
    v_add_u32 v167, s38, v169
    v_mul_u32_u24 v167, 1280, v167
    v_and_b32 v168, 15, v0
    v_lshlrev_b32 v169, 1, v169
    v_xor_b32 v168, v168, v169
    v_lshl_add_u32 v167, v168, 4, v167
    s_lshl_b32 s38, s22, 8
    v_add_u32 v167, s38, v167
    v_xor_b32 v168, 8, v168
    v_and_b32 v170, 0xffffff0f, v167
    v_and_b32 v168, 15, v168
    v_lshl_add_u32 v170, v168, 4, v170
    s_lshl_b32 s39, s22, 13
    s_add_u32 s39, s39, 24576
    s_mov_b32 m0, s39
    s_mov_b32 s38, 0
L_k2_s_wo:
    buffer_load_dwordx4 v167, s[28:31], s38 offen lds
    s_add_u32 m0, m0, 1024
    s_add_u32 s38, s38, 5120
    buffer_load_dwordx4 v167, s[28:31], s38 offen lds
    s_add_u32 m0, m0, 1024
    s_add_u32 s38, s38, 5120
    buffer_load_dwordx4 v170, s[28:31], s38 offen lds
    s_add_u32 m0, m0, 1024
    s_add_u32 s38, s38, 5120
    buffer_load_dwordx4 v170, s[28:31], s38 offen lds
    s_add_u32 m0, m0, 1024
    s_add_u32 s38, s38, 5120
    s_cmp_lt_u32 s38, 40960
    s_cbranch_scc1 L_k2_s_wo
L_k2_s_nowo:
    s_cmp_eq_u32 s22, 0
    s_cbranch_scc0 L_da_33
    v_mov_b32 v124, 163732
L_own_34:
    ds_read_b32 v125, v124
    s_waitcnt lgkmcnt(0)
    v_cmp_le_u32 vcc, 1, v125
    s_nop 0
    s_cbranch_vccnz L_ownd_35
    s_branch L_own_34
L_ownd_35:
    s_add_u32 s92, s12, 23379968
    s_addc_u32 s93, s13, 0
    s_mov_b32 s94, 40960
    s_mov_b32 s95, 0x20000
    s_lshl_b32 s99, s2, 7
    s_add_u32 s99, s99, 8192
    v_and_b32 v124, 1, v254
    v_lshlrev_b32 v124, 2, v124
    v_add_u32 v124, s99, v124
    v_mov_b32 v126, 1
    s_mov_b64 exec, 3
    s_mov_b32 s99, 0
L_pl_36:
    buffer_load_dword v125, v124, s[92:95], 0 offen sc1
    s_waitcnt vmcnt(0)
    v_cmp_ge_u32 vcc, v125, v126
    s_add_u32 s99, s99, 1
    s_nop 0
    s_cmp_eq_u64 vcc, exec
    s_cbranch_scc1 L_pld_37
    s_cmp_lt_u32 s99, 262144
    s_cbranch_scc1 L_pl_36
L_pld_37:
    s_mov_b64 exec, -1
L_da_33:
    s_barrier
    v_cmp_gt_u32 vcc, 20, v0
    buffer_load_dwordx4 v[44:47], v166, s[32:35], s44 offen sc1
    buffer_load_dwordx4 v[76:79], v166, s[32:35], s45 offen sc1
    buffer_load_dwordx4 v[48:51], v164, s[32:35], s46 offen sc1
    buffer_load_dwordx4 v[52:55], v165, s[32:35], s46 offen sc1
    buffer_load_dwordx4 v[64:67], v164, s[32:35], s47 offen sc1
    buffer_load_dwordx4 v[68:71], v165, s[32:35], s47 offen sc1
    s_mov_b32 s38, 0
    buffer_load_dwordx4 v[4:7], v1, s[32:35], s38 offen sc1
    s_add_u32 s38, s38, 32768
    buffer_load_dwordx4 v[8:11], v1, s[32:35], s38 offen sc1
    s_add_u32 s38, s38, 32768
    buffer_load_dwordx4 v[12:15], v1, s[32:35], s38 offen sc1
    s_add_u32 s38, s38, 32768
    buffer_load_dwordx4 v[16:19], v1, s[32:35], s38 offen sc1
    s_add_u32 s38, s38, 32768
    buffer_load_dwordx4 v[20:23], v1, s[32:35], s38 offen sc1
    s_add_u32 s38, s38, 32768
    buffer_load_dwordx4 v[24:27], v1, s[32:35], s38 offen sc1
    s_add_u32 s38, s38, 32768
    buffer_load_dwordx4 v[28:31], v1, s[32:35], s38 offen sc1
    s_add_u32 s38, s38, 32768
    buffer_load_dwordx4 v[32:35], v1, s[32:35], s38 offen sc1
    s_add_u32 s38, s38, 32768
    buffer_load_dwordx4 v[36:39], v1, s[32:35], s38 offen sc1
    s_add_u32 s38, s38, 32768
    buffer_load_dwordx4 v[40:43], v1, s[32:35], s38 offen sc1
    s_mul_i32 s38, s22, 320
    v_add_u32 v167, s38, v164
    s_mul_i32 s38, s22, 1664
    v_add_u32 v168, s38, v164
    s_waitcnt vmcnt(10)
    v_pk_add_f32 v[44:45], v[44:45], v[76:77]
    v_pk_add_f32 v[46:47], v[46:47], v[78:79]
    v_pk_add_f32 v[48:49], v[48:49], v[64:65]
    v_pk_add_f32 v[50:51], v[50:51], v[66:67]
    v_pk_add_f32 v[52:53], v[52:53], v[68:69]
    v_pk_add_f32 v[54:55], v[54:55], v[70:71]
    ds_write_b128 v168, v[48:51] offset:5120
    s_and_saveexec_b64 s[42:43], vcc
    ds_write_b128 v167, v[44:47] offset:0
    s_mov_b64 exec, s[40:41]
    ds_write_b128 v168, v[52:55] offset:6144
    s_mov_b64 exec, s[42:43]
    s_waitcnt lgkmcnt(0)
    s_barrier
    ds_read_b128 v[80:83], v164 offset:0
    ds_read_b128 v[84:87], v164 offset:320
    ds_read_b128 v[88:91], v164 offset:640
    ds_read_b128 v[92:95], v164 offset:960
    ds_read_b128 v[96:99], v164 offset:1280
    ds_read_b128 v[100:103], v164 offset:1600
    ds_read_b128 v[104:107], v164 offset:1920
    ds_read_b128 v[108:111], v164 offset:2240
    s_waitcnt lgkmcnt(0)
    v_pk_add_f32 v[80:81], v[80:81], v[84:85]
    v_pk_add_f32 v[82:83], v[82:83], v[86:87]
    v_pk_add_f32 v[80:81], v[80:81], v[88:89]
    v_pk_add_f32 v[82:83], v[82:83], v[90:91]
    v_pk_add_f32 v[80:81], v[80:81], v[92:93]
    v_pk_add_f32 v[82:83], v[82:83], v[94:95]
    v_pk_add_f32 v[80:81], v[80:81], v[96:97]
    v_pk_add_f32 v[82:83], v[82:83], v[98:99]
    v_pk_add_f32 v[80:81], v[80:81], v[100:101]
    v_pk_add_f32 v[82:83], v[82:83], v[102:103]
    v_pk_add_f32 v[80:81], v[80:81], v[104:105]
    v_pk_add_f32 v[82:83], v[82:83], v[106:107]
    v_pk_add_f32 v[80:81], v[80:81], v[108:109]
    v_pk_add_f32 v[82:83], v[82:83], v[110:111]
    s_and_saveexec_b64 s[42:43], vcc
    ds_write_b128 v167, v[80:83] offset:2560
    s_mov_b64 exec, s[42:43]
    s_cmp_ge_u32 s22, 2
    s_cbranch_scc1 L_k2_s_nokv
    s_lshl_b32 s38, s22, 6
    v_add_u32 v169, s38, v0
    v_lshlrev_b32 v170, 4, v169
    ds_read_b128 v[80:83], v170 offset:5120
    ds_read_b128 v[84:87], v170 offset:6784
    ds_read_b128 v[88:91], v170 offset:8448
    ds_read_b128 v[92:95], v170 offset:10112
    ds_read_b128 v[96:99], v170 offset:11776
    ds_read_b128 v[100:103], v170 offset:13440
    ds_read_b128 v[104:107], v170 offset:15104
    ds_read_b128 v[108:111], v170 offset:16768
    v_mul_u32_u24 v170, 13108, v169
    v_lshrrev_b32 v170, 16, v170
    v_mul_u32_u24 v171, 5, v170
    v_sub_u32 v171, v169, v171
    v_lshlrev_b32 v170, 6, v170
    v_lshl_add_u32 v170, v171, 3, v170
    v_cmp_gt_u32 vcc, 100, v169
    s_waitcnt lgkmcnt(0)
    v_pk_add_f32 v[80:81], v[80:81], v[84:85]
    v_pk_add_f32 v[82:83], v[82:83], v[86:87]
    v_pk_add_f32 v[80:81], v[80:81], v[88:89]
    v_pk_add_f32 v[82:83], v[82:83], v[90:91]
    v_pk_add_f32 v[80:81], v[80:81], v[92:93]
    v_pk_add_f32 v[82:83], v[82:83], v[94:95]
    v_pk_add_f32 v[80:81], v[80:81], v[96:97]
    v_pk_add_f32 v[82:83], v[82:83], v[98:99]
    v_pk_add_f32 v[80:81], v[80:81], v[100:101]
    v_pk_add_f32 v[82:83], v[82:83], v[102:103]
    v_pk_add_f32 v[80:81], v[80:81], v[104:105]
    v_pk_add_f32 v[82:83], v[82:83], v[106:107]
    v_pk_add_f32 v[80:81], v[80:81], v[108:109]
    v_pk_add_f32 v[82:83], v[82:83], v[110:111]
    v_cvt_pk_bf16_f32 v80, v80, v81
    v_cvt_pk_bf16_f32 v81, v82, v83
    s_and_saveexec_b64 s[42:43], vcc
    ds_write_b64 v170, v[80:81] offset:20480
    s_mov_b64 exec, s[42:43]
L_k2_s_nokv:
    s_waitcnt vmcnt(0) lgkmcnt(0)
    s_barrier
    s_cmp_ge_u32 s22, 5
    s_cbranch_scc1 L_k2_s_pqn
    v_and_b32 v144, 15, v0
    v_lshrrev_b32 v145, 4, v0
    v_lshlrev_b32 v146, 6, v144
    v_lshl_add_u32 v146, v145, 4, v146
    ds_read_b128 v[44:47], v146 offset:20480
    ds_read_b128 v[48:51], v146 offset:21504
    v_lshrrev_b32 v150, 2, v144
    v_lshl_add_u32 v147, v145, 3, v150
    v_lshlrev_b32 v147, 8, v147
    v_and_b32 v148, 3, v144
    v_lshl_add_u32 v147, v148, 3, v147
    s_lshl_b32 s39, s22, 13
    s_add_u32 s38, s39, 24576
    v_add_u32 v147, s38, v147
    v_and_b32 v148, 1, v145
    v_lshl_add_u32 v150, v148, 2, v150
    v_xor_b32 v151, 0, v150
    v_lshl_add_u32 v151, v151, 5, v147
    ds_read_b64_tr_b16 v[80:81], v151 offset:0
    ds_read_b64_tr_b16 v[82:83], v151 offset:1024
    v_xor_b32 v151, 1, v150
    v_lshl_add_u32 v151, v151, 5, v147
    ds_read_b64_tr_b16 v[84:85], v151 offset:0
    ds_read_b64_tr_b16 v[86:87], v151 offset:1024
    v_xor_b32 v151, 2, v150
    v_lshl_add_u32 v151, v151, 5, v147
    ds_read_b64_tr_b16 v[88:89], v151 offset:0
    ds_read_b64_tr_b16 v[90:91], v151 offset:1024
    v_xor_b32 v151, 3, v150
    v_lshl_add_u32 v151, v151, 5, v147
    ds_read_b64_tr_b16 v[92:93], v151 offset:0
    ds_read_b64_tr_b16 v[94:95], v151 offset:1024
    v_xor_b32 v151, 4, v150
    v_lshl_add_u32 v151, v151, 5, v147
    ds_read_b64_tr_b16 v[96:97], v151 offset:0
    ds_read_b64_tr_b16 v[98:99], v151 offset:1024
    v_xor_b32 v151, 5, v150
    v_lshl_add_u32 v151, v151, 5, v147
    ds_read_b64_tr_b16 v[100:101], v151 offset:0
    ds_read_b64_tr_b16 v[102:103], v151 offset:1024
    s_waitcnt lgkmcnt(8)
    v_xor_b32 v151, 6, v150
    v_lshl_add_u32 v151, v151, 5, v147
    ds_read_b64_tr_b16 v[104:105], v151 offset:0
    ds_read_b64_tr_b16 v[106:107], v151 offset:1024
    v_xor_b32 v151, 7, v150
    v_lshl_add_u32 v151, v151, 5, v147
    ds_read_b64_tr_b16 v[108:109], v151 offset:0
    ds_read_b64_tr_b16 v[110:111], v151 offset:1024
    v_and_b32 v148, 1, v145
    v_lshrrev_b32 v149, 1, v145
    v_lshl_add_u32 v149, v148, 1, v149
    v_xor_b32 v149, v149, v144
    v_lshlrev_b32 v149, 4, v149
    v_lshl_add_u32 v149, v144, 8, v149
    s_add_u32 s38, s39, 69632
    v_add_u32 v149, s38, v149
    s_mov_b32 s48, 0
    s_waitcnt lgkmcnt(0)
L_k2_s_dt:
    v_mfma_f32_16x16x32_bf16 v[112:115], v[80:83], v[44:47], 0
    v_mfma_f32_16x16x32_bf16 v[116:119], v[84:87], v[44:47], 0
    v_mfma_f32_16x16x32_bf16 v[120:123], v[88:91], v[44:47], 0
    v_mfma_f32_16x16x32_bf16 v[124:127], v[92:95], v[44:47], 0
    v_mfma_f32_16x16x32_bf16 v[128:131], v[96:99], v[44:47], 0
    v_mfma_f32_16x16x32_bf16 v[132:135], v[100:103], v[44:47], 0
    v_mfma_f32_16x16x32_bf16 v[136:139], v[104:107], v[44:47], 0
    v_mfma_f32_16x16x32_bf16 v[140:143], v[108:111], v[44:47], 0
    v_mov_b32 v44, v48
    v_mov_b32 v45, v49
    v_mov_b32 v46, v50
    v_mov_b32 v47, v51
    s_nop 3
    v_cvt_pk_bf16_f32 v152, v112, v113
    v_cvt_pk_bf16_f32 v153, v114, v115
    v_cvt_pk_bf16_f32 v154, v116, v117
    v_cvt_pk_bf16_f32 v155, v118, v119
    s_nop 1
    v_permlane16_swap_b32 v152, v154
    v_permlane16_swap_b32 v153, v155
    v_xor_b32 v150, 0, v149
    ds_write_b128 v150, v[152:155]
    v_cvt_pk_bf16_f32 v156, v120, v121
    v_cvt_pk_bf16_f32 v157, v122, v123
    v_cvt_pk_bf16_f32 v158, v124, v125
    v_cvt_pk_bf16_f32 v159, v126, v127
    s_nop 1
    v_permlane16_swap_b32 v156, v158
    v_permlane16_swap_b32 v157, v159
    v_xor_b32 v150, 64, v149
    ds_write_b128 v150, v[156:159]
    v_cvt_pk_bf16_f32 v152, v128, v129
    v_cvt_pk_bf16_f32 v153, v130, v131
    v_cvt_pk_bf16_f32 v154, v132, v133
    v_cvt_pk_bf16_f32 v155, v134, v135
    s_nop 1
    v_permlane16_swap_b32 v152, v154
    v_permlane16_swap_b32 v153, v155
    v_xor_b32 v150, 128, v149
    ds_write_b128 v150, v[152:155]
    v_cvt_pk_bf16_f32 v156, v136, v137
    v_cvt_pk_bf16_f32 v157, v138, v139
    v_cvt_pk_bf16_f32 v158, v140, v141
    v_cvt_pk_bf16_f32 v159, v142, v143
    s_nop 1
    v_permlane16_swap_b32 v156, v158
    v_permlane16_swap_b32 v157, v159
    v_xor_b32 v150, 192, v149
    ds_write_b128 v150, v[156:159]
    v_add_u32 v149, 0x1000, v149
    s_add_u32 s48, s48, 1
    s_cmp_lt_u32 s48, 2
    s_cbranch_scc1 L_k2_s_dt
    v_lshlrev_b32 v144, 4, v0
    v_add_u32 v144, s38, v144
    v_lshrrev_b32 v145, 4, v0
    s_mul_i32 s39, s20, 20
    v_add_u32 v145, s39, v145
    v_mul_u32_u24 v145, 1280, v145
    s_lshl_b32 s39, s22, 8
    s_add_u32 s39, s39, 20185088
    v_add_u32 v145, s39, v145
    v_and_b32 v146, 15, v0
    v_lshrrev_b32 v147, 4, v0
    v_xor_b32 v146, v146, v147
    s_mov_b32 s39, 0
    s_waitcnt lgkmcnt(0)
    ds_read_b128 v[80:83], v144 offset:0
    ds_read_b128 v[84:87], v144 offset:1024
    ds_read_b128 v[88:91], v144 offset:2048
    ds_read_b128 v[92:95], v144 offset:3072
    ds_read_b128 v[96:99], v144 offset:4096
    v_xor_b32 v147, 0, v146
    v_lshl_add_u32 v148, v147, 4, v145
    s_waitcnt lgkmcnt(4)
    buffer_store_dwordx4 v[80:83], v148, s[32:35], s39 offen sc1
    s_add_u32 s39, s39, 5120
    v_xor_b32 v147, 4, v146
    v_lshl_add_u32 v149, v147, 4, v145
    s_waitcnt lgkmcnt(3)
    buffer_store_dwordx4 v[84:87], v149, s[32:35], s39 offen sc1
    s_add_u32 s39, s39, 5120
    v_xor_b32 v147, 8, v146
    v_lshl_add_u32 v148, v147, 4, v145
    s_waitcnt lgkmcnt(2)
    buffer_store_dwordx4 v[88:91], v148, s[32:35], s39 offen sc1
    s_add_u32 s39, s39, 5120
    v_xor_b32 v147, 12, v146
    v_lshl_add_u32 v149, v147, 4, v145
    s_waitcnt lgkmcnt(1)
    buffer_store_dwordx4 v[92:95], v149, s[32:35], s39 offen sc1
    s_add_u32 s39, s39, 5120
    v_xor_b32 v147, 0, v146
    v_lshl_add_u32 v148, v147, 4, v145
    s_waitcnt lgkmcnt(0)
    buffer_store_dwordx4 v[96:99], v148, s[32:35], s39 offen sc1
    s_add_u32 s39, s39, 5120
L_k2_s_pqn:
    s_mul_i32 s38, s22, 320
    s_add_u32 s38, s38, 2560
    v_mov_b32 v167, s38
    s_mov_b32 s48, 0
    s_mov_b32 s44, 0x358637bd
L_k2_s_head:
    ds_read_b128 v[112:115], v167 offset:0
    ds_read_b128 v[116:119], v167 offset:16
    ds_read_b128 v[120:123], v167 offset:32
    ds_read_b128 v[124:127], v167 offset:48
    ds_read_b128 v[128:131], v167 offset:64
    s_set_gpr_idx_on s48, 0x2
    s_nop 0
    v_lshlrev_b32 v80, 16, v4
    v_and_b32 v81, 0xffff0000, v4
    v_lshlrev_b32 v82, 16, v5
    v_and_b32 v83, 0xffff0000, v5
    v_lshlrev_b32 v84, 16, v6
    v_and_b32 v85, 0xffff0000, v6
    v_lshlrev_b32 v86, 16, v7
    v_and_b32 v87, 0xffff0000, v7
    v_lshlrev_b32 v88, 16, v8
    v_and_b32 v89, 0xffff0000, v8
    v_lshlrev_b32 v90, 16, v9
    v_and_b32 v91, 0xffff0000, v9
    v_lshlrev_b32 v92, 16, v10
    v_and_b32 v93, 0xffff0000, v10
    v_lshlrev_b32 v94, 16, v11
    v_and_b32 v95, 0xffff0000, v11
    v_lshlrev_b32 v96, 16, v12
    v_and_b32 v97, 0xffff0000, v12
    v_lshlrev_b32 v98, 16, v13
    v_and_b32 v99, 0xffff0000, v13
    s_set_gpr_idx_off
    v_add_u32 v167, 0x50, v167
    s_waitcnt lgkmcnt(0)
    v_pk_mul_f32 v[104:105], v[80:81], v[112:113]
    v_pk_mul_f32 v[106:107], v[82:83], v[114:115]
    v_pk_fma_f32 v[104:105], v[84:85], v[116:117], v[104:105]
    v_pk_fma_f32 v[106:107], v[86:87], v[118:119], v[106:107]
    v_pk_fma_f32 v[104:105], v[88:89], v[120:121], v[104:105]
    v_pk_fma_f32 v[106:107], v[90:91], v[122:123], v[106:107]
    v_pk_fma_f32 v[104:105], v[92:93], v[124:125], v[104:105]
    v_pk_fma_f32 v[106:107], v[94:95], v[126:127], v[106:107]
    v_pk_fma_f32 v[104:105], v[96:97], v[128:129], v[104:105]
    v_pk_fma_f32 v[106:107], v[98:99], v[130:131], v[106:107]
    v_pk_add_f32 v[104:105], v[104:105], v[106:107]
    v_add_f32 v105, s44, v105
    v_add_f32 v104, v104, v105
    v_rcp_f32 v104, v104
    s_nop 0
    v_pk_mul_f32 v[80:81], v[80:81], v[104:105] op_sel_hi:[1,0]
    v_pk_mul_f32 v[82:83], v[82:83], v[104:105] op_sel_hi:[1,0]
    v_pk_mul_f32 v[84:85], v[84:85], v[104:105] op_sel_hi:[1,0]
    v_pk_mul_f32 v[86:87], v[86:87], v[104:105] op_sel_hi:[1,0]
    v_pk_mul_f32 v[88:89], v[88:89], v[104:105] op_sel_hi:[1,0]
    v_pk_mul_f32 v[90:91], v[90:91], v[104:105] op_sel_hi:[1,0]
    v_pk_mul_f32 v[92:93], v[92:93], v[104:105] op_sel_hi:[1,0]
    v_pk_mul_f32 v[94:95], v[94:95], v[104:105] op_sel_hi:[1,0]
    v_pk_mul_f32 v[96:97], v[96:97], v[104:105] op_sel_hi:[1,0]
    v_pk_mul_f32 v[98:99], v[98:99], v[104:105] op_sel_hi:[1,0]
    s_set_gpr_idx_on s48, 0x8
    s_nop 0
    v_cvt_pk_bf16_f32 v4, v80, v81
    v_cvt_pk_bf16_f32 v5, v82, v83
    v_cvt_pk_bf16_f32 v6, v84, v85
    v_cvt_pk_bf16_f32 v7, v86, v87
    v_cvt_pk_bf16_f32 v8, v88, v89
    v_cvt_pk_bf16_f32 v9, v90, v91
    v_cvt_pk_bf16_f32 v10, v92, v93
    v_cvt_pk_bf16_f32 v11, v94, v95
    v_cvt_pk_bf16_f32 v12, v96, v97
    v_cvt_pk_bf16_f32 v13, v98, v99
    s_set_gpr_idx_off
    s_add_u32 s48, s48, 10
    s_cmp_lt_u32 s48, 40
    s_cbranch_scc1 L_k2_s_head
    s_mov_b32 s46, 7864320
    buffer_store_dwordx4 v[4:7], v1, s[32:35], s46 offen sc1
    s_add_u32 s46, s46, 32768
    buffer_store_dwordx4 v[8:11], v1, s[32:35], s46 offen sc1
    s_add_u32 s46, s46, 32768
    buffer_store_dwordx4 v[12:15], v1, s[32:35], s46 offen sc1
    s_add_u32 s46, s46, 32768
    buffer_store_dwordx4 v[16:19], v1, s[32:35], s46 offen sc1
    s_add_u32 s46, s46, 32768
    buffer_store_dwordx4 v[20:23], v1, s[32:35], s46 offen sc1
    s_add_u32 s46, s46, 32768
    buffer_store_dwordx4 v[24:27], v1, s[32:35], s46 offen sc1
    s_add_u32 s46, s46, 32768
    buffer_store_dwordx4 v[28:31], v1, s[32:35], s46 offen sc1
    s_add_u32 s46, s46, 32768
    buffer_store_dwordx4 v[32:35], v1, s[32:35], s46 offen sc1
    s_add_u32 s46, s46, 32768
    buffer_store_dwordx4 v[36:39], v1, s[32:35], s46 offen sc1
    s_add_u32 s46, s46, 32768
    buffer_store_dwordx4 v[40:43], v1, s[32:35], s46 offen sc1
L_k2_side_done:
    s_waitcnt vmcnt(0)
    s_barrier
    s_cmp_eq_u32 s22, 0
    s_cbranch_scc0 L_dl_38
    s_add_u32 s92, s12, 23379968
    s_addc_u32 s93, s13, 0
    s_mov_b32 s94, 40960
    s_mov_b32 s95, 0x20000
    v_mov_b32 v124, 2816
    v_mov_b32 v125, 1
    s_mov_b64 exec, 1
    buffer_atomic_add v125, v124, s[92:95], 0 offen sc0 sc1
    s_waitcnt vmcnt(0)
    v_readfirstlane_b32 s99, v125
    s_mov_b64 exec, -1
    s_cmp_eq_u32 s99, 31
    s_cbranch_scc0 L_arr_39
    v_and_b32 v124, 63, v254
    v_lshlrev_b32 v124, 7, v124
    v_add_u32 v124, 8200, v124
    v_mov_b32 v125, 1
    buffer_store_dword v125, v124, s[92:95], 0 offen sc1
    v_add_u32 v124, 0x2000, v124
    buffer_store_dword v125, v124, s[92:95], 0 offen sc1
    v_add_u32 v124, 0x2000, v124
    buffer_store_dword v125, v124, s[92:95], 0 offen sc1
    v_add_u32 v124, 0x2000, v124
    buffer_store_dword v125, v124, s[92:95], 0 offen sc1
L_arr_39:
    v_mov_b32 v124, 163732
    v_mov_b32 v125, 2
    ds_write_b32 v124, v125
L_dl_38:
    s_branch L_phase3
L_k2_idle:
    s_cmp_eq_u32 s22, 0
    s_cbranch_scc0 L_di_40
    v_mov_b32 v124, 163732
    v_mov_b32 v125, 2
    ds_write_b32 v124, v125
L_di_40:
    s_branch L_phase3
L_phase3:
    v_mov_b32 v0, v254
    s_load_dwordx2 s[4:5], s[0:1], 48
    s_load_dwordx2 s[6:7], s[0:1], 0
    s_load_dwordx2 s[8:9], s[0:1], 64
    s_load_dwordx2 s[12:13], s[0:1], 88
    v_lshrrev_b32 v1, 6, v0
    v_and_b32 v0, 63, v0
    s_and_b32 s16, s2, 7
    s_lshr_b32 s17, s2, 3
    v_readfirstlane_b32 s22, v1
    s_cmp_ge_u32 s17, 28
    s_cbranch_scc1 L_k3_gate
    s_and_b32 s19, s16, 3
    s_mul_i32 s19, s19, 28
    s_add_u32 s19, s19, s17
    s_lshr_b32 s21, s19, 3
    s_and_b32 s49, s19, 7
    s_lshr_b32 s20, s16, 2
    s_lshl_b32 s20, s20, 3
    s_add_u32 s20, s20, s49
    s_mul_i32 s44, s21, 3
    s_add_u32 s49, s49, s44
    s_mul_i32 s44, s49, 6554
    s_lshr_b32 s44, s44, 16
    s_mul_i32 s44, s44, 10
    s_sub_u32 s49, s49, s44
    s_cmp_lt_u32 s22, 4
    s_cbranch_scc1 L_k3_compute
    s_setprio 0
    s_sub_u32 s22, s22, 4
    s_lshl_b32 s36, s20, 7
    s_lshl_b32 s37, s22, 16
    s_add_u32 s37, s37, 4096
    v_add_u32 v11, s36, v0
    v_lshlrev_b32 v11, 4, v11
    v_add_u32 v2, s37, v11
    v_mov_b32 v3, v2
    v_add_u32 v4, 30720, v2
    v_mov_b32 v5, v4
    v_lshrrev_b32 v11, 4, v0
    s_lshl_b32 s36, s22, 4
    v_add_u32 v12, s36, v11
    v_mul_u32_u24 v12, 3456, v12
    s_lshl_b32 s36, s21, 8
    v_add_u32 v12, s36, v12
    v_lshlrev_b32 v11, 1, v11
    v_and_b32 v13, 15, v0
    v_xor_b32 v11, v11, v13
    v_lshl_add_u32 v6, v11, 4, v12
    v_add_u32 v12, 12800, v12
    v_lshl_add_u32 v7, v11, 4, v12
    v_add_u32 v12, 12800, v12
    v_xor_b32 v11, 8, v11
    v_lshl_add_u32 v8, v11, 4, v12
    v_add_u32 v12, 12800, v12
    v_lshl_add_u32 v9, v11, 4, v12
    s_mul_i32 s49, s49, 1
    s_lshl_b32 s36, s49, 18
    s_mul_i32 s37, s49, 221184
    s_lshl_b32 s42, s22, 12
    s_add_u32 s43, s42, 61440
    s_mov_b32 s40, s42
    s_mov_b32 s60, s43
    s_add_u32 s62, s42, 49152
    s_add_u32 s63, s43, 98304
    s_waitcnt lgkmcnt(0)
    s_add_u32 s24, s12, 5238784
    s_addc_u32 s25, s13, 0
    s_mov_b32 s26, 2625536
    s_mov_b32 s27, 0x20000
    s_mov_b32 s28, s4
    s_mov_b32 s29, s5
    s_mov_b32 s30, 2211840
    s_mov_b32 s31, 0x20000
    s_mov_b32 s32, s12
    s_mov_b32 s33, s13
    s_mov_b32 s34, 23379968
    s_mov_b32 s35, 0x20000
    v_mov_b32 v30, 163732
L_own_41:
    ds_read_b32 v31, v30
    s_waitcnt lgkmcnt(0)
    v_cmp_le_u32 vcc, 2, v31
    s_nop 0
    s_cbranch_vccnz L_ownd_42
    s_branch L_own_41
L_ownd_42:
    s_mov_b32 s46, 0
L_k3b_preB:
    s_mov_b32 m0, s60
    s_add_u32 s60, s60, 16384
    buffer_load_dwordx4 v6, s[28:31], s37 offen offset:0 lds
    buffer_load_dwordx4 v7, s[28:31], s37 offen offset:1024 lds
    buffer_load_dwordx4 v8, s[28:31], s37 offen offset:2048 lds
    buffer_load_dwordx4 v9, s[28:31], s37 offen offset:3072 lds
    s_cmp_eq_u32 s60, s63
    s_cselect_b32 s60, s43, s60
    s_add_u32 s37, s37, 221184
    s_cmp_eq_u32 s37, 2211840
    s_cselect_b32 s37, 0, s37
    s_add_u32 s46, s46, 1
    s_cmp_lt_u32 s46, 3
    s_cbranch_scc1 L_k3b_preB
    s_cmp_eq_u32 s22, 0
    s_cbranch_scc0 L_dw_43
    v_mov_b32 v30, 163732
L_own_45:
    ds_read_b32 v31, v30
    s_waitcnt lgkmcnt(0)
    v_cmp_le_u32 vcc, 2, v31
    s_nop 0
    s_cbranch_vccnz L_ownd_46
    s_branch L_own_45
L_ownd_46:
    s_add_u32 s92, s12, 23379968
    s_addc_u32 s93, s13, 0
    s_mov_b32 s94, 40960
    s_mov_b32 s95, 0x20000
    s_lshl_b32 s44, s20, 7
    s_mul_i32 s45, s44, 10923
    s_lshr_b32 s45, s45, 20
    s_add_u32 s44, s44, 127
    s_mul_i32 s44, s44, 10923
    s_lshr_b32 s44, s44, 20
    s_min_u32 s44, s44, 21
    v_and_b32 v33, 63, v254
    v_add_u32 v30, s45, v33
    v_min_u32 v30, s44, v30
    v_add_u32 v30, 0, v30
    v_lshlrev_b32 v30, 7, v30
    v_mov_b32 v32, 10
    s_mov_b64 exec, 15
    s_mov_b32 s99, 0
L_pl_47:
    buffer_load_dword v31, v30, s[92:95], 0 offen sc1
    s_waitcnt vmcnt(0)
    v_cmp_ge_u32 vcc, v31, v32
    s_add_u32 s99, s99, 1
    s_nop 0
    s_cmp_eq_u64 vcc, exec
    s_cbranch_scc1 L_pld_48
    s_cmp_lt_u32 s99, 262144
    s_cbranch_scc1 L_pl_47
L_pld_48:
    s_mov_b64 exec, -1
    v_mov_b32 v30, 163728
    v_mov_b32 v31, 2
    ds_write_b32 v30, v31
    s_branch L_dwd_44
L_dw_43:
    v_mov_b32 v30, 163728
L_dep_49:
    ds_read_b32 v31, v30
    s_waitcnt lgkmcnt(0)
    v_cmp_le_u32 vcc, 2, v31
    s_nop 0
    s_cbranch_vccnz L_depd_50
    s_branch L_dep_49
L_depd_50:
L_dwd_44:
    s_mov_b32 s46, 0
L_k3b_preA:
    s_mov_b32 m0, s40
    s_add_u32 s40, s40, 16384
    buffer_load_dwordx4 v2, s[24:27], s36 offen offset:0 sc1 lds
    buffer_load_dwordx4 v3, s[24:27], s36 offen offset:1024 sc1 lds
    buffer_load_dwordx4 v4, s[24:27], s36 offen offset:2048 sc1 lds
    buffer_load_dwordx4 v5, s[24:27], s36 offen offset:3072 sc1 lds
    s_cmp_eq_u32 s40, s62
    s_cselect_b32 s40, s42, s40
    s_add_u32 s36, s36, 262144
    s_cmp_eq_u32 s36, 2621440
    s_cselect_b32 s36, 0, s36
    s_add_u32 s46, s46, 1
    s_cmp_lt_u32 s46, 2
    s_cbranch_scc1 L_k3b_preA
    s_waitcnt vmcnt(4)
    s_barrier
    s_mov_b32 m0, s40
    s_add_u32 s40, s40, 16384
    buffer_load_dwordx4 v2, s[24:27], s36 offen offset:0 sc1 lds
    buffer_load_dwordx4 v3, s[24:27], s36 offen offset:1024 sc1 lds
    buffer_load_dwordx4 v4, s[24:27], s36 offen offset:2048 sc1 lds
    buffer_load_dwordx4 v5, s[24:27], s36 offen offset:3072 sc1 lds
    s_cmp_eq_u32 s40, s62
    s_cselect_b32 s40, s42, s40
    s_add_u32 s36, s36, 262144
    s_cmp_eq_u32 s36, 2621440
    s_cselect_b32 s36, 0, s36
    s_mov_b32 m0, s60
    s_add_u32 s60, s60, 16384
    buffer_load_dwordx4 v6, s[28:31], s37 offen offset:0 lds
    buffer_load_dwordx4 v7, s[28:31], s37 offen offset:1024 lds
    buffer_load_dwordx4 v8, s[28:31], s37 offen offset:2048 lds
    buffer_load_dwordx4 v9, s[28:31], s37 offen offset:3072 lds
    s_cmp_eq_u32 s60, s63
    s_cselect_b32 s60, s43, s60
    s_add_u32 s37, s37, 221184
    s_cmp_eq_u32 s37, 2211840
    s_cselect_b32 s37, 0, s37
    s_waitcnt vmcnt(8)
    s_barrier
    s_mov_b32 m0, s40
    s_add_u32 s40, s40, 16384
    buffer_load_dwordx4 v2, s[24:27], s36 offen offset:0 sc1 lds
    buffer_load_dwordx4 v3, s[24:27], s36 offen offset:1024 sc1 lds
    buffer_load_dwordx4 v4, s[24:27], s36 offen offset:2048 sc1 lds
    buffer_load_dwordx4 v5, s[24:27], s36 offen offset:3072 sc1 lds
    s_cmp_eq_u32 s40, s62
    s_cselect_b32 s40, s42, s40
    s_add_u32 s36, s36, 262144
    s_cmp_eq_u32 s36, 2621440
    s_cselect_b32 s36, 0, s36
    s_mov_b32 m0, s60
    s_add_u32 s60, s60, 16384
    buffer_load_dwordx4 v6, s[28:31], s37 offen offset:0 lds
    buffer_load_dwordx4 v7, s[28:31], s37 offen offset:1024 lds
    buffer_load_dwordx4 v8, s[28:31], s37 offen offset:2048 lds
    buffer_load_dwordx4 v9, s[28:31], s37 offen offset:3072 lds
    s_cmp_eq_u32 s60, s63
    s_cselect_b32 s60, s43, s60
    s_add_u32 s37, s37, 221184
    s_cmp_eq_u32 s37, 2211840
    s_cselect_b32 s37, 0, s37
    s_mov_b32 s46, 0
L_k3b_seg2:
    s_waitcnt vmcnt(12)
    s_barrier
    s_mov_b32 m0, s40
    s_add_u32 s40, s40, 16384
    buffer_load_dwordx4 v2, s[24:27], s36 offen offset:0 sc1 lds
    buffer_load_dwordx4 v3, s[24:27], s36 offen offset:1024 sc1 lds
    buffer_load_dwordx4 v4, s[24:27], s36 offen offset:2048 sc1 lds
    buffer_load_dwordx4 v5, s[24:27], s36 offen offset:3072 sc1 lds
    s_cmp_eq_u32 s40, s62
    s_cselect_b32 s40, s42, s40
    s_add_u32 s36, s36, 262144
    s_cmp_eq_u32 s36, 2621440
    s_cselect_b32 s36, 0, s36
    s_mov_b32 m0, s60
    s_add_u32 s60, s60, 16384
    buffer_load_dwordx4 v6, s[28:31], s37 offen offset:0 lds
    buffer_load_dwordx4 v7, s[28:31], s37 offen offset:1024 lds
    buffer_load_dwordx4 v8, s[28:31], s37 offen offset:2048 lds
    buffer_load_dwordx4 v9, s[28:31], s37 offen offset:3072 lds
    s_cmp_eq_u32 s60, s63
    s_cselect_b32 s60, s43, s60
    s_add_u32 s37, s37, 221184
    s_cmp_eq_u32 s37, 2211840
    s_cselect_b32 s37, 0, s37
    s_add_u32 s46, s46, 1
    s_cmp_lt_u32 s46, 5
    s_cbranch_scc1 L_k3b_seg2
    s_waitcnt vmcnt(12)
    s_barrier
    s_mov_b32 m0, s40
    s_add_u32 s40, s40, 16384
    buffer_load_dwordx4 v2, s[24:27], s36 offen offset:0 sc1 lds
    buffer_load_dwordx4 v3, s[24:27], s36 offen offset:1024 sc1 lds
    buffer_load_dwordx4 v4, s[24:27], s36 offen offset:2048 sc1 lds
    buffer_load_dwordx4 v5, s[24:27], s36 offen offset:3072 sc1 lds
    s_cmp_eq_u32 s40, s62
    s_cselect_b32 s40, s42, s40
    s_add_u32 s36, s36, 262144
    s_cmp_eq_u32 s36, 2621440
    s_cselect_b32 s36, 0, s36
    s_waitcnt vmcnt(8)
    s_barrier
    s_lshl_b32 s44, s20, 7
    s_lshl_b32 s45, s22, 5
    s_add_u32 s44, s44, s45
    v_add_u32 v11, s44, v0
    v_lshlrev_b32 v11, 3, v11
    v_add_u32 v11, 21905408, v11
    v_mov_b32 v12, 0x80000000
    v_cmp_gt_u32 vcc, 32, v0
    s_mov_b32 s44, 0
    s_nop 0
    v_cndmask_b32 v11, v12, v11, vcc
    buffer_load_dwordx2 v[40:41], v11, s[32:35], s44 offen sc1
    s_add_u32 s44, s44, 16384
    buffer_load_dwordx2 v[42:43], v11, s[32:35], s44 offen sc1
    s_add_u32 s44, s44, 16384
    buffer_load_dwordx2 v[44:45], v11, s[32:35], s44 offen sc1
    s_add_u32 s44, s44, 16384
    buffer_load_dwordx2 v[46:47], v11, s[32:35], s44 offen sc1
    s_add_u32 s44, s44, 16384
    buffer_load_dwordx2 v[48:49], v11, s[32:35], s44 offen sc1
    s_add_u32 s44, s44, 16384
    buffer_load_dwordx2 v[50:51], v11, s[32:35], s44 offen sc1
    s_add_u32 s44, s44, 16384
    buffer_load_dwordx2 v[52:53], v11, s[32:35], s44 offen sc1
    s_add_u32 s44, s44, 16384
    buffer_load_dwordx2 v[54:55], v11, s[32:35], s44 offen sc1
    s_add_u32 s44, s44, 16384
    buffer_load_dwordx2 v[56:57], v11, s[32:35], s44 offen sc1
    s_add_u32 s44, s44, 16384
    buffer_load_dwordx2 v[58:59], v11, s[32:35], s44 offen sc1
    s_waitcnt vmcnt(10)
    s_barrier
    s_waitcnt vmcnt(0)
    v_pk_add_f32 v[40:41], v[40:41], v[42:43]
    v_pk_add_f32 v[40:41], v[40:41], v[44:45]
    v_pk_add_f32 v[40:41], v[40:41], v[46:47]
    v_pk_add_f32 v[40:41], v[40:41], v[48:49]
    v_pk_add_f32 v[40:41], v[40:41], v[50:51]
    v_pk_add_f32 v[40:41], v[40:41], v[52:53]
    v_pk_add_f32 v[40:41], v[40:41], v[54:55]
    v_pk_add_f32 v[40:41], v[40:41], v[56:57]
    v_pk_add_f32 v[40:41], v[40:41], v[58:59]
    s_mov_b32 s44, 0xbacccccd
    s_mov_b32 s45, 0x3acccccd
    v_mul_f32 v44, s44, v40
    v_mul_f32 v45, s45, v41
    s_mov_b32 s44, 0x3727c5ac
    v_fma_f32 v45, -v44, v44, v45
    v_max_f32 v45, 0, v45
    v_add_f32 v45, s44, v45
    v_rsq_f32 v46, v45
    v_sqrt_f32 v45, v45
    s_mov_b32 s44, 0xbdd2d3e8
    s_mov_b32 s45, 0xc0135761
    v_mul_f32 v47, v46, v46
    v_mul_f32 v47, v47, v46
    v_mul_f32 v47, s44, v47
    v_mul_f32 v46, s45, v46
    s_lshl_b32 s44, s22, 9
    s_add_u32 s44, s44, 143360
    v_lshlrev_b32 v11, 4, v0
    v_add_u32 v11, s44, v11
    v_cmp_gt_u32 vcc, 32, v0
    s_and_saveexec_b64 s[44:45], vcc
    ds_write_b128 v11, v[44:47]
    s_mov_b64 exec, s[44:45]
    s_waitcnt lgkmcnt(0)
    s_barrier
    s_branch L_phase4
L_k3_compute:
    s_setprio 0
    v_mov_b32 v255, v0
    s_lshr_b32 s36, s22, 1
    s_and_b32 s37, s22, 1
    v_and_b32 v208, 15, v0
    v_lshrrev_b32 v209, 4, v0
    v_lshlrev_b32 v210, 11, v209
    v_lshl_add_u32 v210, v208, 4, v210
    s_lshl_b32 s38, s36, 10
    v_add_u32 v128, s38, v210
    v_lshrrev_b32 v210, 2, v208
    v_lshlrev_b32 v211, 3, v209
    v_add_u32 v211, v211, v210
    v_lshlrev_b32 v211, 8, v211
    v_and_b32 v212, 3, v208
    v_lshl_add_u32 v211, v212, 3, v211
    v_add_u32 v211, 61440, v211
    v_and_b32 v212, 1, v209
    v_xor_b32 v212, s37, v212
    v_lshl_add_u32 v211, v212, 7, v211
    v_xor_b32 v213, 0, v210
    v_lshl_add_u32 v129, v213, 5, v211
    v_xor_b32 v213, 1, v210
    v_lshl_add_u32 v130, v213, 5, v211
    v_xor_b32 v213, 2, v210
    v_lshl_add_u32 v131, v213, 5, v211
    v_xor_b32 v213, 3, v210
    v_lshl_add_u32 v132, v213, 5, v211
    s_lshl_b32 s38, s36, 10
    s_add_u32 s38, s38, 143360
    v_lshl_add_u32 v159, v208, 4, s38
    v_and_b32 v215, 1, v209
    v_lshrrev_b32 v216, 1, v209
    v_lshl_add_u32 v216, v215, 1, v216
    s_lshl_b32 s38, s21, 4
    s_lshl_b32 s39, s37, 3
    s_add_u32 s38, s38, s39
    v_add_u32 v216, s38, v216
    v_lshlrev_b32 v216, 15, v216
    s_lshl_b32 s38, s20, 7
    s_lshl_b32 s39, s36, 6
    s_add_u32 s38, s38, s39
    v_add_u32 v213, s38, v208
    v_lshl_add_u32 v156, v213, 4, v216
    v_lshlrev_b32 v217, 4, v209
    v_add_u32 v217, 60416, v217
    s_lshl_b32 s38, s22, 8
    v_add_u32 v157, s38, v217
    s_xor_b32 s38, s38, 512
    v_add_u32 v158, s38, v217
    s_waitcnt lgkmcnt(0)
    s_mov_b32 s32, s12
    s_mov_b32 s33, s13
    s_mov_b32 s34, 23379968
    s_mov_b32 s35, 0x20000
    s_add_u32 s44, s12, 13107200
    s_addc_u32 s45, s13, 0
    s_mov_b32 s46, 7077888
    s_mov_b32 s47, 0x20000
    v_mov_b32 v0, 0
    v_mov_b32 v1, 0
    v_mov_b32 v2, 0
    v_mov_b32 v3, 0
    v_mov_b32 v4, 0
    v_mov_b32 v5, 0
    v_mov_b32 v6, 0
    v_mov_b32 v7, 0
    v_mov_b32 v8, 0
    v_mov_b32 v9, 0
    v_mov_b32 v10, 0
    v_mov_b32 v11, 0
    v_mov_b32 v12, 0
    v_mov_b32 v13, 0
    v_mov_b32 v14, 0
    v_mov_b32 v15, 0
    v_mov_b32 v16, 0
    v_mov_b32 v17, 0
    v_mov_b32 v18, 0
    v_mov_b32 v19, 0
    v_mov_b32 v20, 0
    v_mov_b32 v21, 0
    v_mov_b32 v22, 0
    v_mov_b32 v23, 0
    v_mov_b32 v24, 0
    v_mov_b32 v25, 0
    v_mov_b32 v26, 0
    v_mov_b32 v27, 0
    v_mov_b32 v28, 0
    v_mov_b32 v29, 0
    v_mov_b32 v30, 0
    v_mov_b32 v31, 0
    v_mov_b32 v32, 0
    v_mov_b32 v33, 0
    v_mov_b32 v34, 0
    v_mov_b32 v35, 0
    v_mov_b32 v36, 0
    v_mov_b32 v37, 0
    v_mov_b32 v38, 0
    v_mov_b32 v39, 0
    v_mov_b32 v40, 0
    v_mov_b32 v41, 0
    v_mov_b32 v42, 0
    v_mov_b32 v43, 0
    v_mov_b32 v44, 0
    v_mov_b32 v45, 0
    v_mov_b32 v46, 0
    v_mov_b32 v47, 0
    v_mov_b32 v48, 0
    v_mov_b32 v49, 0
    v_mov_b32 v50, 0
    v_mov_b32 v51, 0
    v_mov_b32 v52, 0
    v_mov_b32 v53, 0
    v_mov_b32 v54, 0
    v_mov_b32 v55, 0
    v_mov_b32 v56, 0
    v_mov_b32 v57, 0
    v_mov_b32 v58, 0
    v_mov_b32 v59, 0
    v_mov_b32 v60, 0
    v_mov_b32 v61, 0
    v_mov_b32 v62, 0
    v_mov_b32 v63, 0
    v_mov_b32 v136, 0
    v_mov_b32 v137, 0
    v_mov_b32 v138, 0
    v_mov_b32 v139, 0
    v_mov_b32 v140, 0
    v_mov_b32 v141, 0
    v_mov_b32 v142, 0
    v_mov_b32 v143, 0
    v_mov_b32 v144, 0
    v_mov_b32 v145, 0
    v_mov_b32 v146, 0
    v_mov_b32 v147, 0
    v_mov_b32 v148, 0
    v_mov_b32 v149, 0
    v_mov_b32 v150, 0
    v_mov_b32 v151, 0
    v_mov_b32 v152, 0x3f803f80
    v_mov_b32 v153, 0x3f803f80
    v_mov_b32 v154, 0x3f803f80
    v_mov_b32 v155, 0x3f803f80
    s_mov_b32 s61, 0
    s_mov_b32 s60, 131072
    s_cmp_eq_u32 s36, 0
    s_cselect_b64 vcc, -1, 0
    s_mov_b32 s40, 0
    s_mov_b32 s41, 0
    s_mov_b32 s51, 0
    s_barrier
    ds_read_b64_tr_b16 v[80:81], v129 offset:0
    ds_read_b64_tr_b16 v[82:83], v129 offset:1024
    ds_read_b128 v[64:67], v128 offset:0
    ds_read_b128 v[68:71], v128 offset:256
    ds_read_b128 v[72:75], v128 offset:512
    ds_read_b128 v[76:79], v128 offset:768
    ds_read_b64_tr_b16 v[84:85], v130 offset:0
    ds_read_b64_tr_b16 v[86:87], v130 offset:1024
    ds_read_b64_tr_b16 v[88:89], v131 offset:0
    ds_read_b64_tr_b16 v[90:91], v131 offset:1024
    ds_read_b64_tr_b16 v[92:93], v132 offset:0
    ds_read_b64_tr_b16 v[94:95], v132 offset:1024
    s_waitcnt lgkmcnt(0)
L_k3_main:
    v_mfma_f32_16x16x32_bf16 v[0:3], v[80:83], v[64:67], v[0:3]
    ds_read_b64_tr_b16 v[112:113], v129 offset:8192
    v_mfma_f32_16x16x32_bf16 v[16:19], v[80:83], v[68:71], v[16:19]
    ds_read_b64_tr_b16 v[114:115], v129 offset:9216
    v_mfma_f32_16x16x32_bf16 v[32:35], v[80:83], v[72:75], v[32:35]
    ds_read_b128 v[96:99], v128 offset:8192
    v_mfma_f32_16x16x32_bf16 v[48:51], v[80:83], v[76:79], v[48:51]
    ds_read_b128 v[100:103], v128 offset:8448
    v_mfma_f32_16x16x32_bf16 v[4:7], v[84:87], v[64:67], v[4:7]
    ds_read_b128 v[104:107], v128 offset:8704
    v_mfma_f32_16x16x32_bf16 v[20:23], v[84:87], v[68:71], v[20:23]
    ds_read_b128 v[108:111], v128 offset:8960
    v_mfma_f32_16x16x32_bf16 v[36:39], v[84:87], v[72:75], v[36:39]
    ds_read_b64_tr_b16 v[116:117], v130 offset:8192
    v_mfma_f32_16x16x32_bf16 v[52:55], v[84:87], v[76:79], v[52:55]
    ds_read_b64_tr_b16 v[118:119], v130 offset:9216
    v_mfma_f32_16x16x32_bf16 v[8:11], v[88:91], v[64:67], v[8:11]
    ds_read_b64_tr_b16 v[120:121], v131 offset:8192
    v_mfma_f32_16x16x32_bf16 v[24:27], v[88:91], v[68:71], v[24:27]
    ds_read_b64_tr_b16 v[122:123], v131 offset:9216
    v_mfma_f32_16x16x32_bf16 v[40:43], v[88:91], v[72:75], v[40:43]
    ds_read_b64_tr_b16 v[124:125], v132 offset:8192
    v_mfma_f32_16x16x32_bf16 v[56:59], v[88:91], v[76:79], v[56:59]
    ds_read_b64_tr_b16 v[126:127], v132 offset:9216
    s_add_u32 s40, s40, 1
    s_add_u32 s41, s41, 1
    v_mfma_f32_16x16x32_bf16 v[12:15], v[92:95], v[64:67], v[12:15]
    s_add_u32 s51, s51, 1
    s_movk_i32 s42, 16384
    v_mfma_f32_16x16x32_bf16 v[28:31], v[92:95], v[68:71], v[28:31]
    s_cmp_eq_u32 s41, 3
    s_cselect_b32 s42, 0xffff8000, s42
    v_mfma_f32_16x16x32_bf16 v[44:47], v[92:95], v[72:75], v[44:47]
    s_cselect_b32 s41, 0, s41
    v_add_u32 v128, s42, v128
    v_mfma_f32_16x16x32_bf16 v[60:63], v[92:95], v[76:79], v[60:63]
    s_movk_i32 s42, 16384
    s_cmp_eq_u32 s51, 6
    s_cselect_b32 s42, 0xfffec000, s42
    s_cselect_b32 s51, 0, s51
    v_add_u32 v129, s42, v129
    v_add_u32 v130, s42, v130
    v_add_u32 v131, s42, v131
    v_add_u32 v132, s42, v132
    s_cmp_eq_u32 s40, 10
    s_cbranch_vccz L_k3_nocs0
    v_mfma_f32_16x16x32_bf16 v[136:139], v[80:83], v[152:155], v[136:139]
    v_mfma_f32_16x16x32_bf16 v[140:143], v[84:87], v[152:155], v[140:143]
    v_mfma_f32_16x16x32_bf16 v[144:147], v[88:91], v[152:155], v[144:147]
    v_mfma_f32_16x16x32_bf16 v[148:151], v[92:95], v[152:155], v[148:151]
L_k3_nocs0:
    s_waitcnt lgkmcnt(0)
    s_cbranch_scc1 L_k3_nobar
    s_barrier
L_k3_nobar:
    v_mfma_f32_16x16x32_bf16 v[0:3], v[112:115], v[96:99], v[0:3]
    ds_read_b64_tr_b16 v[80:81], v129 offset:0
    v_mfma_f32_16x16x32_bf16 v[16:19], v[112:115], v[100:103], v[16:19]
    ds_read_b64_tr_b16 v[82:83], v129 offset:1024
    v_mfma_f32_16x16x32_bf16 v[32:35], v[112:115], v[104:107], v[32:35]
    ds_read_b128 v[64:67], v128 offset:0
    v_mfma_f32_16x16x32_bf16 v[48:51], v[112:115], v[108:111], v[48:51]
    ds_read_b128 v[68:71], v128 offset:256
    v_mfma_f32_16x16x32_bf16 v[4:7], v[116:119], v[96:99], v[4:7]
    ds_read_b128 v[72:75], v128 offset:512
    v_mfma_f32_16x16x32_bf16 v[20:23], v[116:119], v[100:103], v[20:23]
    ds_read_b128 v[76:79], v128 offset:768
    v_mfma_f32_16x16x32_bf16 v[36:39], v[116:119], v[104:107], v[36:39]
    ds_read_b64_tr_b16 v[84:85], v130 offset:0
    v_mfma_f32_16x16x32_bf16 v[52:55], v[116:119], v[108:111], v[52:55]
    ds_read_b64_tr_b16 v[86:87], v130 offset:1024
    v_mfma_f32_16x16x32_bf16 v[8:11], v[120:123], v[96:99], v[8:11]
    ds_read_b64_tr_b16 v[88:89], v131 offset:0
    v_mfma_f32_16x16x32_bf16 v[24:27], v[120:123], v[100:103], v[24:27]
    ds_read_b64_tr_b16 v[90:91], v131 offset:1024
    v_mfma_f32_16x16x32_bf16 v[40:43], v[120:123], v[104:107], v[40:43]
    ds_read_b64_tr_b16 v[92:93], v132 offset:0
    v_mfma_f32_16x16x32_bf16 v[56:59], v[120:123], v[108:111], v[56:59]
    ds_read_b64_tr_b16 v[94:95], v132 offset:1024
    v_mfma_f32_16x16x32_bf16 v[12:15], v[124:127], v[96:99], v[12:15]
    v_mfma_f32_16x16x32_bf16 v[28:31], v[124:127], v[100:103], v[28:31]
    v_mfma_f32_16x16x32_bf16 v[44:47], v[124:127], v[104:107], v[44:47]
    v_mfma_f32_16x16x32_bf16 v[60:63], v[124:127], v[108:111], v[60:63]
    s_cbranch_vccnz L_k3_nocs1
    v_mfma_f32_16x16x32_bf16 v[136:139], v[112:115], v[152:155], v[136:139]
    v_mfma_f32_16x16x32_bf16 v[140:143], v[116:119], v[152:155], v[140:143]
    v_mfma_f32_16x16x32_bf16 v[144:147], v[120:123], v[152:155], v[144:147]
    v_mfma_f32_16x16x32_bf16 v[148:151], v[124:127], v[152:155], v[148:151]
L_k3_nocs1:
    s_waitcnt lgkmcnt(0)
    s_cbranch_scc0 L_k3_main
    s_barrier
    s_nop 2
    ds_write_b128 v157, v[136:139] offset:0
    ds_write_b128 v157, v[140:143] offset:64
    ds_write_b128 v157, v[144:147] offset:128
    ds_write_b128 v157, v[148:151] offset:192
    ds_read_b128 v[108:111], v159
    s_mov_b32 s43, 0
    s_mov_b32 s50, 0
    s_mov_b32 s60, 131072
    s_waitcnt lgkmcnt(0)
    s_add_u32 s98, s98, 1
    s_lshl_b32 s99, s22, 2
    s_add_u32 s99, s99, 163712
    v_mov_b32 v234, s99
    v_mov_b32 v235, s98
    s_waitcnt lgkmcnt(0)
    ds_write_b32 v234, v235
    v_mov_b32 v234, 163712
L_csync_51:
    ds_read_b128 v[230:233], v234
    s_waitcnt lgkmcnt(0)
    v_min_u32 v230, v230, v231
    v_min_u32 v232, v232, v233
    v_min_u32 v230, v230, v232
    v_cmp_le_u32 vcc, v235, v230
    s_nop 0
    s_cbranch_vccz L_csync_51
    ds_read_b128 v[64:67], v158 offset:0
    ds_read_b128 v[68:71], v158 offset:64
    ds_read_b128 v[72:75], v158 offset:128
    ds_read_b128 v[76:79], v158 offset:192
    s_waitcnt lgkmcnt(0)
    v_pk_add_f32 v[136:137], v[136:137], v[64:65]
    v_pk_add_f32 v[138:139], v[138:139], v[66:67]
    v_pk_add_f32 v[140:141], v[140:141], v[68:69]
    v_pk_add_f32 v[142:143], v[142:143], v[70:71]
    v_pk_add_f32 v[144:145], v[144:145], v[72:73]
    v_pk_add_f32 v[146:147], v[146:147], v[74:75]
    v_pk_add_f32 v[148:149], v[148:149], v[76:77]
    v_pk_add_f32 v[150:151], v[150:151], v[78:79]
L_k3_h_loop:
    s_waitcnt lgkmcnt(0)
    s_set_gpr_idx_on s50, 0x4
    s_nop 0
    v_fma_f32 v64, v136, v108, v0
    v_fma_f32 v65, v137, v108, v1
    v_fma_f32 v66, v138, v108, v2
    v_fma_f32 v67, v139, v108, v3
    v_fma_f32 v68, v140, v108, v4
    v_fma_f32 v69, v141, v108, v5
    v_fma_f32 v70, v142, v108, v6
    v_fma_f32 v71, v143, v108, v7
    v_fma_f32 v72, v144, v108, v8
    v_fma_f32 v73, v145, v108, v9
    v_fma_f32 v74, v146, v108, v10
    v_fma_f32 v75, v147, v108, v11
    v_fma_f32 v76, v148, v108, v12
    v_fma_f32 v77, v149, v108, v13
    v_fma_f32 v78, v150, v108, v14
    v_fma_f32 v79, v151, v108, v15
    s_set_gpr_idx_off
    v_pk_mul_f32 v[80:81], v[64:65], v[64:65]
    v_pk_mul_f32 v[82:83], v[66:67], v[66:67]
    v_pk_mul_f32 v[84:85], v[68:69], v[68:69]
    v_pk_mul_f32 v[86:87], v[70:71], v[70:71]
    v_pk_mul_f32 v[88:89], v[72:73], v[72:73]
    v_pk_mul_f32 v[90:91], v[74:75], v[74:75]
    v_pk_mul_f32 v[92:93], v[76:77], v[76:77]
    v_pk_mul_f32 v[94:95], v[78:79], v[78:79]
    v_pk_fma_f32 v[80:81], v[80:81], v[110:111], v[110:111] op_sel:[0,1,0] op_sel_hi:[1,1,0]
    v_pk_fma_f32 v[82:83], v[82:83], v[110:111], v[110:111] op_sel:[0,1,0] op_sel_hi:[1,1,0]
    v_pk_fma_f32 v[84:85], v[84:85], v[110:111], v[110:111] op_sel:[0,1,0] op_sel_hi:[1,1,0]
    v_pk_fma_f32 v[86:87], v[86:87], v[110:111], v[110:111] op_sel:[0,1,0] op_sel_hi:[1,1,0]
    v_pk_fma_f32 v[88:89], v[88:89], v[110:111], v[110:111] op_sel:[0,1,0] op_sel_hi:[1,1,0]
    v_pk_fma_f32 v[90:91], v[90:91], v[110:111], v[110:111] op_sel:[0,1,0] op_sel_hi:[1,1,0]
    v_pk_fma_f32 v[92:93], v[92:93], v[110:111], v[110:111] op_sel:[0,1,0] op_sel_hi:[1,1,0]
    v_pk_fma_f32 v[94:95], v[94:95], v[110:111], v[110:111] op_sel:[0,1,0] op_sel_hi:[1,1,0]
    v_pk_mul_f32 v[80:81], v[80:81], v[64:65]
    v_pk_mul_f32 v[82:83], v[82:83], v[66:67]
    v_pk_mul_f32 v[84:85], v[84:85], v[68:69]
    v_pk_mul_f32 v[86:87], v[86:87], v[70:71]
    v_pk_mul_f32 v[88:89], v[88:89], v[72:73]
    v_pk_mul_f32 v[90:91], v[90:91], v[74:75]
    v_pk_mul_f32 v[92:93], v[92:93], v[76:77]
    v_pk_mul_f32 v[94:95], v[94:95], v[78:79]
    v_exp_f32 v80, v80
    v_exp_f32 v81, v81
    v_exp_f32 v82, v82
    v_exp_f32 v83, v83
    v_exp_f32 v84, v84
    v_exp_f32 v85, v85
    v_exp_f32 v86, v86
    v_exp_f32 v87, v87
    v_exp_f32 v88, v88
    v_exp_f32 v89, v89
    v_exp_f32 v90, v90
    v_exp_f32 v91, v91
    v_exp_f32 v92, v92
    v_exp_f32 v93, v93
    v_exp_f32 v94, v94
    v_exp_f32 v95, v95
    v_pk_fma_f32 v[80:81], v[80:81], v[108:109], v[108:109] op_sel:[0,1,1] op_sel_hi:[1,1,1]
    v_pk_fma_f32 v[82:83], v[82:83], v[108:109], v[108:109] op_sel:[0,1,1] op_sel_hi:[1,1,1]
    v_pk_fma_f32 v[84:85], v[84:85], v[108:109], v[108:109] op_sel:[0,1,1] op_sel_hi:[1,1,1]
    v_pk_fma_f32 v[86:87], v[86:87], v[108:109], v[108:109] op_sel:[0,1,1] op_sel_hi:[1,1,1]
    v_pk_fma_f32 v[88:89], v[88:89], v[108:109], v[108:109] op_sel:[0,1,1] op_sel_hi:[1,1,1]
    v_pk_fma_f32 v[90:91], v[90:91], v[108:109], v[108:109] op_sel:[0,1,1] op_sel_hi:[1,1,1]
    v_pk_fma_f32 v[92:93], v[92:93], v[108:109], v[108:109] op_sel:[0,1,1] op_sel_hi:[1,1,1]
    v_pk_fma_f32 v[94:95], v[94:95], v[108:109], v[108:109] op_sel:[0,1,1] op_sel_hi:[1,1,1]
    v_rcp_f32 v80, v80
    v_rcp_f32 v81, v81
    v_rcp_f32 v82, v82
    v_rcp_f32 v83, v83
    v_rcp_f32 v84, v84
    v_rcp_f32 v85, v85
    v_rcp_f32 v86, v86
    v_rcp_f32 v87, v87
    v_rcp_f32 v88, v88
    v_rcp_f32 v89, v89
    v_rcp_f32 v90, v90
    v_rcp_f32 v91, v91
    v_rcp_f32 v92, v92
    v_rcp_f32 v93, v93
    v_rcp_f32 v94, v94
    v_rcp_f32 v95, v95
    v_pk_mul_f32 v[64:65], v[64:65], v[80:81]
    v_pk_mul_f32 v[66:67], v[66:67], v[82:83]
    v_pk_mul_f32 v[68:69], v[68:69], v[84:85]
    v_pk_mul_f32 v[70:71], v[70:71], v[86:87]
    v_pk_mul_f32 v[72:73], v[72:73], v[88:89]
    v_pk_mul_f32 v[74:75], v[74:75], v[90:91]
    v_pk_mul_f32 v[76:77], v[76:77], v[92:93]
    v_pk_mul_f32 v[78:79], v[78:79], v[94:95]
    v_add_u32 v159, 256, v159
    ds_read_b128 v[108:111], v159
    v_cvt_pk_bf16_f32 v96, v64, v65
    v_cvt_pk_bf16_f32 v97, v66, v67
    v_cvt_pk_bf16_f32 v98, v68, v69
    v_cvt_pk_bf16_f32 v99, v70, v71
    v_cvt_pk_bf16_f32 v100, v72, v73
    v_cvt_pk_bf16_f32 v101, v74, v75
    v_cvt_pk_bf16_f32 v102, v76, v77
    v_cvt_pk_bf16_f32 v103, v78, v79
    s_add_u32 s48, s43, s60
    v_permlane16_swap_b32 v96, v98
    v_permlane16_swap_b32 v97, v99
    v_permlane16_swap_b32 v100, v102
    v_permlane16_swap_b32 v101, v103
    buffer_store_dwordx4 v[96:99], v156, s[44:47], s43 offen sc1
    buffer_store_dwordx4 v[100:103], v156, s[44:47], s48 offen sc1
    s_add_u32 s43, s43, 256
    s_add_u32 s50, s50, 16
    s_cmp_lt_u32 s50, 64
    s_cbranch_scc1 L_k3_h_loop
    s_add_u32 s38, s20, 23
    s_add_u32 s91, s38, 1
    s_branch L_phase4
L_k3_gate:
    s_waitcnt lgkmcnt(0)
    s_mov_b32 s32, s12
    s_mov_b32 s33, s13
    s_mov_b32 s34, 23379968
    s_mov_b32 s35, 0x20000
    s_mov_b32 s24, s6
    s_mov_b32 s25, s7
    s_mov_b32 s26, 2621440
    s_mov_b32 s27, 0x20000
    s_mov_b32 s28, s8
    s_mov_b32 s29, s9
    s_mov_b32 s30, 1280
    s_mov_b32 s31, 0x20000
    s_sub_u32 s20, s17, 28
    s_lshl_b32 s20, s20, 3
    s_add_u32 s20, s20, s16
    s_lshl_b32 s20, s20, 3
    s_add_u32 s20, s20, s22
    v_and_b32 v60, 15, v0
    v_lshlrev_b32 v60, 4, v60
    v_lshrrev_b32 v61, 4, v0
    v_mul_u32_u24 v62, 1280, v61
    v_add_u32 v62, v62, v60
    buffer_load_dwordx4 v[4:7], v60, s[28:31], 0 offen offset:0
    buffer_load_dwordx4 v[8:11], v60, s[28:31], 0 offen offset:256
    buffer_load_dwordx4 v[12:15], v60, s[28:31], 0 offen offset:512
    buffer_load_dwordx4 v[16:19], v60, s[28:31], 0 offen offset:768
    buffer_load_dwordx4 v[20:23], v60, s[28:31], 0 offen offset:1024
    s_mov_b32 s44, 0xbfb8aa3b
L_k3_gate_loop:
    s_mul_i32 s36, s20, 5120
    buffer_load_dwordx4 v[24:27], v62, s[24:27], s36 offen offset:0
    buffer_load_dwordx4 v[28:31], v62, s[24:27], s36 offen offset:256
    buffer_load_dwordx4 v[32:35], v62, s[24:27], s36 offen offset:512
    buffer_load_dwordx4 v[36:39], v62, s[24:27], s36 offen offset:768
    buffer_load_dwordx4 v[40:43], v62, s[24:27], s36 offen offset:1024
    v_mov_b32 v64, 0
    v_mov_b32 v65, 0
    s_waitcnt vmcnt(0)
    v_dot2_f32_bf16 v64, v24, v4, v64
    v_dot2_f32_bf16 v65, v25, v5, v65
    v_dot2_f32_bf16 v64, v26, v6, v64
    v_dot2_f32_bf16 v65, v27, v7, v65
    v_dot2_f32_bf16 v64, v28, v8, v64
    v_dot2_f32_bf16 v65, v29, v9, v65
    v_dot2_f32_bf16 v64, v30, v10, v64
    v_dot2_f32_bf16 v65, v31, v11, v65
    v_dot2_f32_bf16 v64, v32, v12, v64
    v_dot2_f32_bf16 v65, v33, v13, v65
    v_dot2_f32_bf16 v64, v34, v14, v64
    v_dot2_f32_bf16 v65, v35, v15, v65
    v_dot2_f32_bf16 v64, v36, v16, v64
    v_dot2_f32_bf16 v65, v37, v17, v65
    v_dot2_f32_bf16 v64, v38, v18, v64
    v_dot2_f32_bf16 v65, v39, v19, v65
    v_dot2_f32_bf16 v64, v40, v20, v64
    v_dot2_f32_bf16 v65, v41, v21, v65
    v_dot2_f32_bf16 v64, v42, v22, v64
    v_dot2_f32_bf16 v65, v43, v23, v65
    s_nop 2
    v_add_f32 v64, v64, v65
    s_nop 1
    v_add_f32_dpp v64, v64, v64 row_ror:8 row_mask:0xf bank_mask:0xf
    s_nop 1
    v_add_f32_dpp v64, v64, v64 row_ror:4 row_mask:0xf bank_mask:0xf
    s_nop 1
    v_add_f32_dpp v64, v64, v64 row_ror:2 row_mask:0xf bank_mask:0xf
    s_nop 1
    v_add_f32_dpp v64, v64, v64 row_ror:1 row_mask:0xf bank_mask:0xf
    s_nop 1
    v_mul_f32 v64, s44, v64
    v_exp_f32 v64, v64
    s_nop 0
    v_add_f32 v64, 1.0, v64
    v_rcp_f32 v64, v64
    s_lshl_b32 s36, s20, 4
    s_add_u32 s36, s36, 21897216
    v_lshlrev_b32 v65, 2, v61
    buffer_store_dword v64, v65, s[32:35], s36 offen sc1
    s_add_u32 s20, s20, 256
    s_cmp_lt_u32 s20, 512
    s_cbranch_scc1 L_k3_gate_loop
    s_sub_u32 s44, s17, 28
    s_lshl_b32 s44, s44, 3
    s_add_u32 s44, s44, s16
    s_lshl_b32 s44, s44, 3
    s_add_u32 s44, s44, s22
    s_waitcnt vmcnt(0)
    s_waitcnt vmcnt(0)
    s_barrier
    s_cmp_eq_u32 s22, 0
    s_cbranch_scc0 L_dl_52
    s_add_u32 s92, s12, 23379968
    s_addc_u32 s93, s13, 0
    s_mov_b32 s94, 40960
    s_mov_b32 s95, 0x20000
    v_mov_b32 v100, 4992
    v_mov_b32 v101, 1
    s_mov_b64 exec, 1
    buffer_atomic_add v101, v100, s[92:95], 0 offen sc0 sc1
    s_waitcnt vmcnt(0)
    v_readfirstlane_b32 s99, v101
    s_mov_b64 exec, -1
    s_cmp_eq_u32 s99, 31
    s_cbranch_scc0 L_arr_53
    v_and_b32 v100, 63, v254
    v_lshlrev_b32 v100, 7, v100
    v_add_u32 v100, 8204, v100
    v_mov_b32 v101, 1
    buffer_store_dword v101, v100, s[92:95], 0 offen sc1
    v_add_u32 v100, 0x2000, v100
    buffer_store_dword v101, v100, s[92:95], 0 offen sc1
    v_add_u32 v100, 0x2000, v100
    buffer_store_dword v101, v100, s[92:95], 0 offen sc1
    v_add_u32 v100, 0x2000, v100
    buffer_store_dword v101, v100, s[92:95], 0 offen sc1
L_arr_53:
    v_mov_b32 v100, 163732
    v_mov_b32 v101, 3
    ds_write_b32 v100, v101
L_dl_52:
    s_load_dwordx2 s[92:93], s[0:1], 56
    s_mul_i32 s99, s44, 9216
    v_and_b32 v120, 63, v254
    v_lshlrev_b32 v120, 4, v120
    v_add_u32 v120, s99, v120
    s_mov_b32 s94, 2211840
    s_mov_b32 s95, 0x20000
    s_mov_b32 s99, 0
    s_waitcnt lgkmcnt(0)
L_mw_54:
    buffer_load_dwordx4 v[124:127], v120, s[92:95], s99 offen
    s_add_u32 s99, s99, 1024
    s_cmp_lt_u32 s99, 9216
    s_cbranch_scc1 L_mw_54
    s_waitcnt vmcnt(0)
    s_branch L_phase4
L_phase4:
    v_mov_b32 v0, v254
    s_cmp_ge_u32 s2, 240
    s_cbranch_scc1 L_k4_end
    s_load_dwordx2 s[4:5], s[0:1], 56
    s_load_dwordx2 s[6:7], s[0:1], 72
    s_load_dwordx2 s[12:13], s[0:1], 88
    v_lshrrev_b32 v1, 6, v0
    v_and_b32 v0, 63, v0
    s_and_b32 s16, s2, 7
    s_lshr_b32 s17, s2, 3
    v_readfirstlane_b32 s22, v1
    s_mul_i32 s18, s17, 13108
    s_lshr_b32 s18, s18, 16
    s_mul_i32 s19, s18, 5
    s_sub_u32 s19, s17, s19
    s_lshr_b32 s20, s16, 1
    s_mul_i32 s21, s20, 11
    s_lshr_b32 s23, s21, 1
    s_add_u32 s21, s21, 11
    s_lshr_b32 s21, s21, 1
    s_add_u32 s20, s23, s18
    s_cmp_ge_u32 s20, s21
    s_cbranch_scc1 L_k4_end
    s_and_b32 s21, s16, 1
    s_mul_i32 s21, s21, 5
    s_add_u32 s21, s21, s19
    s_cmp_lt_u32 s22, 4
    s_cbranch_scc1 L_k4_compute
    s_mul_i32 s49, s19, 5
    s_lshl_b32 s44, s18, 2
    s_add_u32 s49, s49, s44
    s_cmp_ge_u32 s49, 27
    s_cselect_b32 s44, 27, 0
    s_sub_u32 s49, s49, s44
    s_setprio 0
    s_sub_u32 s22, s22, 4
    s_mul_i32 s36, s20, 96
    s_lshl_b32 s37, s22, 16
    v_add_u32 v2, s36, v0
    v_mov_b32 v5, s37
    v_cmp_gt_u32 vcc, 32, v0
    v_add_u32 v20, 64, v0
    v_subrev_u32 v21, 32, v0
    v_cndmask_b32 v20, v21, v20, vcc
    v_add_u32 v3, s36, v20
    v_mov_b32 v20, s37
    v_add_u32 v21, 32768, v20
    v_cndmask_b32 v6, v21, v20, vcc
    v_add_u32 v20, 32, v0
    v_add_u32 v4, s36, v20
    v_mov_b32 v7, v21
    v_lshrrev_b32 v20, 3, v0
    s_lshl_b32 s37, s22, 4
    v_add_u32 v20, s37, v20
    v_mul_u32_u24 v20, 1280, v20
    s_lshl_b32 s37, s21, 7
    v_add_u32 v20, s37, v20
    v_bfe_u32 v21, v0, 4, 1
    v_lshlrev_b32 v21, 1, v21
    v_and_b32 v22, 7, v0
    v_xor_b32 v21, v21, v22
    v_lshl_add_u32 v11, v21, 4, v20
    v_xor_b32 v21, 4, v21
    v_lshl_add_u32 v12, v21, 4, v20
    v_add_u32 v12, 10240, v12
    s_mul_i32 s41, s49, 1
    s_lshl_b32 s36, s41, 18
    s_mul_i32 s37, s41, 81920
    s_mul_i32 s42, s22, 3072
    s_lshl_b32 s43, s22, 11
    s_add_u32 s43, s43, 61440
    s_mov_b32 s40, s42
    s_mov_b32 s60, s43
    s_add_u32 s62, s42, 61440
    s_add_u32 s63, s43, 98304
    v_subrev_u32 v12, 0x400, v12
    v_add_u32 v5, 4096, v5
    v_add_u32 v6, 3072, v6
    v_add_u32 v7, 2048, v7
    v_lshl_add_u32 v8, v2, 4, v5
    v_lshl_add_u32 v9, v3, 4, v6
    v_lshl_add_u32 v10, v4, 4, v7
    s_waitcnt lgkmcnt(0)
    s_mov_b32 s32, s12
    s_mov_b32 s33, s13
    s_mov_b32 s34, 23379968
    s_mov_b32 s35, 0x20000
    s_add_u32 s24, s12, 13103104
    s_addc_u32 s25, s13, 0
    s_mov_b32 s26, 7081984
    s_mov_b32 s27, 0x20000
    s_mov_b32 s28, s4
    s_mov_b32 s29, s5
    s_mov_b32 s30, 2211840
    s_mov_b32 s31, 0x20000
    s_add_u32 s48, s12, 5238784
    s_addc_u32 s49, s13, 0
    s_mov_b32 s50, 2625536
    s_mov_b32 s51, 0x20000
    s_add_u32 s52, s12, 7860224
    s_addc_u32 s53, s13, 0
    s_mov_b32 s54, 2625536
    s_mov_b32 s55, 0x20000
    s_add_u32 s56, s12, 20185088
    s_addc_u32 s57, s13, 0
    s_mov_b32 s58, 819200
    s_mov_b32 s59, 0x20000
    s_lshl_b32 s45, s19, 1
    s_add_u32 s45, s45, s18
    s_mul_i32 s44, s45, 6554
    s_lshr_b32 s44, s44, 16
    s_mul_i32 s44, s44, 10
    s_sub_u32 s44, s45, s44
    s_mul_i32 s44, s44, 1
    s_lshl_b32 s41, s44, 18
    s_mul_i32 s61, s44, 81920
    s_cmp_eq_u32 s22, 0
    s_cbranch_scc0 L_dw_55
    s_add_u32 s92, s12, 23379968
    s_addc_u32 s93, s13, 0
    s_mov_b32 s94, 40960
    s_mov_b32 s95, 0x20000
    s_lshl_b32 s44, s2, 7
    s_add_u32 s44, s44, 8200
    v_mov_b32 v30, s44
    v_mov_b32 v32, 1
    s_mov_b64 exec, 15
    s_mov_b32 s99, 0
L_pl_57:
    buffer_load_dword v31, v30, s[92:95], 0 offen sc1
    s_waitcnt vmcnt(0)
    v_cmp_ge_u32 vcc, v31, v32
    s_add_u32 s99, s99, 1
    s_nop 0
    s_cmp_eq_u64 vcc, exec
    s_cbranch_scc1 L_pld_58
    s_cmp_lt_u32 s99, 262144
    s_cbranch_scc1 L_pl_57
L_pld_58:
    s_mov_b64 exec, -1
    v_mov_b32 v30, 163728
    v_mov_b32 v31, 3
    ds_write_b32 v30, v31
    s_branch L_dwd_56
L_dw_55:
    v_mov_b32 v30, 163728
L_dep_59:
    ds_read_b32 v31, v30
    s_waitcnt lgkmcnt(0)
    v_cmp_le_u32 vcc, 3, v31
    s_nop 0
    s_cbranch_vccnz L_depd_60
    s_branch L_dep_59
L_depd_60:
L_dwd_56:
    s_mov_b32 s46, 0
L_k4_preB:
    s_mov_b32 m0, s60
    s_add_u32 s60, s60, 8192
    buffer_load_dwordx4 v11, s[56:59], s61 offen sc1 lds
    buffer_load_dwordx4 v12, s[56:59], s61 offen offset:1024 sc1 lds
    s_cmp_eq_u32 s60, s63
    s_cselect_b32 s60, s43, s60
    s_add_u32 s61, s61, 81920
    s_cmp_eq_u32 s61, 819200
    s_cselect_b32 s61, 0, s61
    s_add_u32 s46, s46, 1
    s_cmp_lt_u32 s46, 3
    s_cbranch_scc1 L_k4_preB
    s_mov_b32 s46, 0
L_k4_preA:
    s_mov_b32 m0, s40
    s_add_u32 s40, s40, 12288
    buffer_load_dwordx4 v8, s[52:55], s41 offen offset:0 sc1 lds
    buffer_load_dwordx4 v9, s[52:55], s41 offen offset:1024 sc1 lds
    buffer_load_dwordx4 v10, s[52:55], s41 offen offset:2048 sc1 lds
    s_cmp_eq_u32 s40, s62
    s_cselect_b32 s40, s42, s40
    s_add_u32 s41, s41, 262144
    s_cmp_eq_u32 s41, 2621440
    s_cselect_b32 s41, 0, s41
    s_add_u32 s46, s46, 1
    s_cmp_lt_u32 s46, 3
    s_cbranch_scc1 L_k4_preA
    s_waitcnt vmcnt(6)
    s_barrier
    s_mov_b32 m0, s40
    s_add_u32 s40, s40, 12288
    buffer_load_dwordx4 v8, s[52:55], s41 offen offset:0 sc1 lds
    buffer_load_dwordx4 v9, s[52:55], s41 offen offset:1024 sc1 lds
    buffer_load_dwordx4 v10, s[52:55], s41 offen offset:2048 sc1 lds
    s_cmp_eq_u32 s40, s62
    s_cselect_b32 s40, s42, s40
    s_add_u32 s41, s41, 262144
    s_cmp_eq_u32 s41, 2621440
    s_cselect_b32 s41, 0, s41
    s_mov_b32 m0, s60
    s_add_u32 s60, s60, 8192
    buffer_load_dwordx4 v11, s[56:59], s61 offen sc1 lds
    buffer_load_dwordx4 v12, s[56:59], s61 offen offset:1024 sc1 lds
    s_cmp_eq_u32 s60, s63
    s_cselect_b32 s60, s43, s60
    s_add_u32 s61, s61, 81920
    s_cmp_eq_u32 s61, 819200
    s_cselect_b32 s61, 0, s61
    s_waitcnt vmcnt(8)
    s_barrier
    s_mov_b32 m0, s40
    s_add_u32 s40, s40, 12288
    buffer_load_dwordx4 v8, s[52:55], s41 offen offset:0 sc1 lds
    buffer_load_dwordx4 v9, s[52:55], s41 offen offset:1024 sc1 lds
    buffer_load_dwordx4 v10, s[52:55], s41 offen offset:2048 sc1 lds
    s_cmp_eq_u32 s40, s62
    s_cselect_b32 s40, s42, s40
    s_add_u32 s41, s41, 262144
    s_cmp_eq_u32 s41, 2621440
    s_cselect_b32 s41, 0, s41
    s_mov_b32 m0, s60
    s_add_u32 s60, s60, 8192
    buffer_load_dwordx4 v11, s[56:59], s61 offen sc1 lds
    buffer_load_dwordx4 v12, s[56:59], s61 offen offset:1024 sc1 lds
    s_cmp_eq_u32 s60, s63
    s_cselect_b32 s60, s43, s60
    s_add_u32 s61, s61, 81920
    s_cmp_eq_u32 s61, 819200
    s_cselect_b32 s61, 0, s61
    s_mov_b32 s46, 0
L_k4_seg2:
    s_waitcnt vmcnt(10)
    s_barrier
    s_mov_b32 m0, s40
    s_add_u32 s40, s40, 12288
    buffer_load_dwordx4 v8, s[52:55], s41 offen offset:0 sc1 lds
    buffer_load_dwordx4 v9, s[52:55], s41 offen offset:1024 sc1 lds
    buffer_load_dwordx4 v10, s[52:55], s41 offen offset:2048 sc1 lds
    s_cmp_eq_u32 s40, s62
    s_cselect_b32 s40, s42, s40
    s_add_u32 s41, s41, 262144
    s_cmp_eq_u32 s41, 2621440
    s_cselect_b32 s41, 0, s41
    s_mov_b32 m0, s60
    s_add_u32 s60, s60, 8192
    buffer_load_dwordx4 v11, s[56:59], s61 offen sc1 lds
    buffer_load_dwordx4 v12, s[56:59], s61 offen offset:1024 sc1 lds
    s_cmp_eq_u32 s60, s63
    s_cselect_b32 s60, s43, s60
    s_add_u32 s61, s61, 81920
    s_cmp_eq_u32 s61, 819200
    s_cselect_b32 s61, 0, s61
    s_add_u32 s46, s46, 1
    s_cmp_lt_u32 s46, 5
    s_cbranch_scc1 L_k4_seg2
    s_waitcnt vmcnt(10)
    s_barrier
    s_mov_b32 s46, 0
L_k4_burst3:
    s_mov_b32 m0, s60
    s_add_u32 s60, s60, 8192
    buffer_load_dwordx4 v11, s[28:31], s37 offen lds
    buffer_load_dwordx4 v12, s[28:31], s37 offen offset:1024 lds
    s_cmp_eq_u32 s60, s63
    s_cselect_b32 s60, s43, s60
    s_add_u32 s37, s37, 81920
    s_cmp_eq_u32 s37, 2211840
    s_cselect_b32 s37, 0, s37
    s_add_u32 s46, s46, 1
    s_cmp_lt_u32 s46, 8
    s_cbranch_scc1 L_k4_burst3
    s_cmp_eq_u32 s22, 0
    s_cbranch_scc0 L_dw_61
    s_add_u32 s92, s12, 23379968
    s_addc_u32 s93, s13, 0
    s_mov_b32 s94, 40960
    s_mov_b32 s95, 0x20000
    s_mul_i32 s44, s20, 96
    s_lshr_b32 s45, s44, 7
    s_add_u32 s44, s44, 95
    s_lshr_b32 s44, s44, 7
    s_min_u32 s44, s44, 15
    s_add_u32 s45, s45, 23
    s_add_u32 s44, s44, 23
    s_lshl_b32 s45, s45, 7
    s_lshl_b32 s44, s44, 7
    s_lshl_b32 s47, s2, 7
    s_add_u32 s47, s47, 8204
    v_mov_b32 v30, s47
    v_mov_b32 v32, 1
    v_and_b32 v33, 63, v254
    v_mov_b32 v34, s45
    v_mov_b32 v35, 14
    v_cmp_eq_u32 vcc, 0, v33
    s_nop 1
    v_cndmask_b32 v30, v30, v34, vcc
    v_cndmask_b32 v32, v32, v35, vcc
    v_mov_b32 v34, s44
    v_cmp_eq_u32 vcc, 1, v33
    s_nop 1
    v_cndmask_b32 v30, v30, v34, vcc
    v_cndmask_b32 v32, v32, v35, vcc
    s_mov_b64 exec, 15
    s_mov_b32 s99, 0
L_pl_63:
    buffer_load_dword v31, v30, s[92:95], 0 offen sc1
    s_waitcnt vmcnt(0)
    v_cmp_ge_u32 vcc, v31, v32
    s_add_u32 s99, s99, 1
    s_nop 0
    s_cmp_eq_u64 vcc, exec
    s_cbranch_scc1 L_pld_64
    s_cmp_lt_u32 s99, 262144
    s_cbranch_scc1 L_pl_63
L_pld_64:
    s_mov_b64 exec, -1
    v_mov_b32 v30, 163728
    v_mov_b32 v31, 4
    ds_write_b32 v30, v31
    s_branch L_dwd_62
L_dw_61:
    v_mov_b32 v30, 163728
L_dep_65:
    ds_read_b32 v31, v30
    s_waitcnt lgkmcnt(0)
    v_cmp_le_u32 vcc, 4, v31
    s_nop 0
    s_cbranch_vccnz L_depd_66
    s_branch L_dep_65
L_depd_66:
L_dwd_62:
    s_mov_b32 m0, s40
    s_add_u32 s40, s40, 12288
    buffer_load_dwordx4 v8, s[24:27], s36 offen offset:0 sc1 lds
    buffer_load_dwordx4 v9, s[24:27], s36 offen offset:1024 sc1 lds
    buffer_load_dwordx4 v10, s[24:27], s36 offen offset:2048 sc1 lds
    s_cmp_eq_u32 s40, s62
    s_cselect_b32 s40, s42, s40
    s_add_u32 s36, s36, 262144
    s_cmp_eq_u32 s36, 7077888
    s_cselect_b32 s36, 0, s36
    s_mov_b32 s46, 0
L_k4_seg4:
    s_waitcnt vmcnt(24)
    s_barrier
    s_mov_b32 m0, s40
    s_add_u32 s40, s40, 12288
    buffer_load_dwordx4 v8, s[24:27], s36 offen offset:0 sc1 lds
    buffer_load_dwordx4 v9, s[24:27], s36 offen offset:1024 sc1 lds
    buffer_load_dwordx4 v10, s[24:27], s36 offen offset:2048 sc1 lds
    s_cmp_eq_u32 s40, s62
    s_cselect_b32 s40, s42, s40
    s_add_u32 s36, s36, 262144
    s_cmp_eq_u32 s36, 7077888
    s_cselect_b32 s36, 0, s36
    s_mov_b32 m0, s60
    s_add_u32 s60, s60, 8192
    buffer_load_dwordx4 v11, s[28:31], s37 offen lds
    buffer_load_dwordx4 v12, s[28:31], s37 offen offset:1024 lds
    s_cmp_eq_u32 s60, s63
    s_cselect_b32 s60, s43, s60
    s_add_u32 s37, s37, 81920
    s_cmp_eq_u32 s37, 2211840
    s_cselect_b32 s37, 0, s37
    s_add_u32 s46, s46, 1
    s_cmp_lt_u32 s46, 2
    s_cbranch_scc1 L_k4_seg4
    s_waitcnt vmcnt(10)
    s_barrier
    s_mov_b32 m0, s40
    s_add_u32 s40, s40, 12288
    buffer_load_dwordx4 v8, s[24:27], s36 offen offset:0 sc1 lds
    buffer_load_dwordx4 v9, s[24:27], s36 offen offset:1024 sc1 lds
    buffer_load_dwordx4 v10, s[24:27], s36 offen offset:2048 sc1 lds
    s_cmp_eq_u32 s40, s62
    s_cselect_b32 s40, s42, s40
    s_add_u32 s36, s36, 262144
    s_cmp_eq_u32 s36, 7077888
    s_cselect_b32 s36, 0, s36
    s_mov_b32 m0, s60
    s_add_u32 s60, s60, 8192
    buffer_load_dwordx4 v11, s[28:31], s37 offen lds
    buffer_load_dwordx4 v12, s[28:31], s37 offen offset:1024 lds
    s_cmp_eq_u32 s60, s63
    s_cselect_b32 s60, s43, s60
    s_add_u32 s37, s37, 81920
    s_cmp_eq_u32 s37, 2211840
    s_cselect_b32 s37, 0, s37
    s_mov_b32 s46, 0
L_k4_seg6:
    s_waitcnt vmcnt(12)
    s_barrier
    s_mov_b32 m0, s40
    s_add_u32 s40, s40, 12288
    buffer_load_dwordx4 v8, s[24:27], s36 offen offset:0 sc1 lds
    buffer_load_dwordx4 v9, s[24:27], s36 offen offset:1024 sc1 lds
    buffer_load_dwordx4 v10, s[24:27], s36 offen offset:2048 sc1 lds
    s_cmp_eq_u32 s40, s62
    s_cselect_b32 s40, s42, s40
    s_add_u32 s36, s36, 262144
    s_cmp_eq_u32 s36, 7077888
    s_cselect_b32 s36, 0, s36
    s_mov_b32 m0, s60
    s_add_u32 s60, s60, 8192
    buffer_load_dwordx4 v11, s[28:31], s37 offen lds
    buffer_load_dwordx4 v12, s[28:31], s37 offen offset:1024 lds
    s_cmp_eq_u32 s60, s63
    s_cselect_b32 s60, s43, s60
    s_add_u32 s37, s37, 81920
    s_cmp_eq_u32 s37, 2211840
    s_cselect_b32 s37, 0, s37
    s_add_u32 s46, s46, 1
    s_cmp_lt_u32 s46, 16
    s_cbranch_scc1 L_k4_seg6
    s_waitcnt vmcnt(12)
    s_barrier
    s_mov_b32 m0, s40
    s_add_u32 s40, s40, 12288
    buffer_load_dwordx4 v8, s[24:27], s36 offen offset:0 sc1 lds
    buffer_load_dwordx4 v9, s[24:27], s36 offen offset:1024 sc1 lds
    buffer_load_dwordx4 v10, s[24:27], s36 offen offset:2048 sc1 lds
    s_cmp_eq_u32 s40, s62
    s_cselect_b32 s40, s42, s40
    s_add_u32 s36, s36, 262144
    s_cmp_eq_u32 s36, 7077888
    s_cselect_b32 s36, 0, s36
    s_waitcnt vmcnt(10)
    s_barrier
    s_mov_b32 m0, s40
    s_add_u32 s40, s40, 12288
    buffer_load_dwordx4 v8, s[24:27], s36 offen offset:0 sc1 lds
    buffer_load_dwordx4 v9, s[24:27], s36 offen offset:1024 sc1 lds
    buffer_load_dwordx4 v10, s[24:27], s36 offen offset:2048 sc1 lds
    s_cmp_eq_u32 s40, s62
    s_cselect_b32 s40, s42, s40
    s_add_u32 s36, s36, 262144
    s_cmp_eq_u32 s36, 7077888
    s_cselect_b32 s36, 0, s36
    s_waitcnt vmcnt(8)
    s_barrier
    s_mov_b32 m0, s40
    s_add_u32 s40, s40, 12288
    buffer_load_dwordx4 v8, s[24:27], s36 offen offset:0 sc1 lds
    buffer_load_dwordx4 v9, s[24:27], s36 offen offset:1024 sc1 lds
    buffer_load_dwordx4 v10, s[24:27], s36 offen offset:2048 sc1 lds
    s_cmp_eq_u32 s40, s62
    s_cselect_b32 s40, s42, s40
    s_add_u32 s36, s36, 262144
    s_cmp_eq_u32 s36, 7077888
    s_cselect_b32 s36, 0, s36
    s_mov_b32 s46, 0
L_k4_seg10:
    s_waitcnt vmcnt(6)
    s_barrier
    s_mov_b32 m0, s40
    s_add_u32 s40, s40, 12288
    buffer_load_dwordx4 v8, s[24:27], s36 offen offset:0 sc1 lds
    buffer_load_dwordx4 v9, s[24:27], s36 offen offset:1024 sc1 lds
    buffer_load_dwordx4 v10, s[24:27], s36 offen offset:2048 sc1 lds
    s_cmp_eq_u32 s40, s62
    s_cselect_b32 s40, s42, s40
    s_add_u32 s36, s36, 262144
    s_cmp_eq_u32 s36, 7077888
    s_cselect_b32 s36, 0, s36
    s_add_u32 s46, s46, 1
    s_cmp_lt_u32 s46, 4
    s_cbranch_scc1 L_k4_seg10
    s_waitcnt vmcnt(6)
    s_barrier
    s_lshl_b32 s44, s21, 18
    s_mul_i32 s45, s22, 3072
    s_add_u32 s45, s45, 94208
    s_mov_b32 m0, s45
    s_nop 0
    buffer_load_dwordx4 v8, s[48:51], s44 offen offset:0 sc1 lds
    buffer_load_dwordx4 v9, s[48:51], s44 offen offset:1024 sc1 lds
    buffer_load_dwordx4 v10, s[48:51], s44 offen offset:2048 sc1 lds
    s_mul_i32 s44, s20, 96
    s_mul_i32 s45, s22, 24
    s_add_u32 s44, s44, s45
    v_add_u32 v20, s44, v0
    v_lshlrev_b32 v20, 2, v20
    s_mul_i32 s45, s22, 96
    s_add_u32 m0, s45, 106496
    s_mov_b32 s44, 21897216
    s_mov_b64 exec, 0xffffff
    buffer_load_dword v20, s[32:35], s44 offen sc1 lds
    s_mov_b64 exec, -1
    s_waitcnt vmcnt(7)
    s_barrier
    s_waitcnt vmcnt(4)
    s_barrier
    s_waitcnt vmcnt(0)
    s_barrier
    s_endpgm
L_k4_compute:
    s_setprio 0
    v_mov_b32 v107, v0
    s_lshr_b32 s36, s22, 1
    s_and_b32 s37, s22, 1
    v_and_b32 v110, 15, v0
    v_lshrrev_b32 v111, 4, v0
    v_mul_u32_u24 v112, 1536, v111
    v_lshl_add_u32 v112, v110, 4, v112
    s_mul_i32 s38, s36, 768
    v_add_u32 v104, s38, v112
    v_lshrrev_b32 v112, 2, v110
    v_lshlrev_b32 v113, 3, v111
    v_add_u32 v113, v113, v112
    v_lshlrev_b32 v113, 7, v113
    v_and_b32 v114, 3, v110
    v_lshl_add_u32 v113, v114, 3, v113
    v_add_u32 v113, 61440, v113
    v_lshrrev_b32 v112, 1, v112
    v_and_b32 v114, 1, v111
    v_lshlrev_b32 v114, 1, v114
    s_lshl_b32 s38, s37, 1
    v_xor_b32 v114, s38, v114
    v_add_u32 v115, v114, v112
    v_lshl_add_u32 v105, v115, 5, v113
    v_xor_b32 v112, 1, v112
    v_add_u32 v115, v114, v112
    v_lshl_add_u32 v106, v115, 5, v113
    v_mov_b32 v0, 0
    v_mov_b32 v1, 0
    v_mov_b32 v2, 0
    v_mov_b32 v3, 0
    v_mov_b32 v4, 0
    v_mov_b32 v5, 0
    v_mov_b32 v6, 0
    v_mov_b32 v7, 0
    v_mov_b32 v8, 0
    v_mov_b32 v9, 0
    v_mov_b32 v10, 0
    v_mov_b32 v11, 0
    v_mov_b32 v12, 0
    v_mov_b32 v13, 0
    v_mov_b32 v14, 0
    v_mov_b32 v15, 0
    v_mov_b32 v16, 0
    v_mov_b32 v17, 0
    v_mov_b32 v18, 0
    v_mov_b32 v19, 0
    v_mov_b32 v20, 0
    v_mov_b32 v21, 0
    v_mov_b32 v22, 0
    v_mov_b32 v23, 0
    v_mov_b32 v168, 0
    v_mov_b32 v169, 0
    v_mov_b32 v170, 0
    v_mov_b32 v171, 0
    v_mov_b32 v172, 0
    v_mov_b32 v173, 0
    v_mov_b32 v174, 0
    v_mov_b32 v175, 0
    v_mov_b32 v176, 0
    v_mov_b32 v177, 0
    v_mov_b32 v178, 0
    v_mov_b32 v179, 0
    v_mov_b32 v180, 0
    v_mov_b32 v181, 0
    v_mov_b32 v182, 0
    v_mov_b32 v183, 0
    v_mov_b32 v184, 0
    v_mov_b32 v185, 0
    v_mov_b32 v186, 0
    v_mov_b32 v187, 0
    v_mov_b32 v188, 0
    v_mov_b32 v189, 0
    v_mov_b32 v190, 0
    v_mov_b32 v191, 0
    s_waitcnt lgkmcnt(0)
    s_mov_b32 s32, s12
    s_mov_b32 s33, s13
    s_mov_b32 s34, 23379968
    s_mov_b32 s35, 0x20000
    s_mov_b32 s56, s6
    s_mov_b32 s57, s7
    s_mov_b32 s58, 2621440
    s_mov_b32 s59, 0x20000
    v_and_b32 v110, 15, v107
    v_lshrrev_b32 v111, 4, v107
    s_mul_i32 s38, s36, 192
    s_add_u32 s38, s38, 106496
    v_lshl_add_u32 v150, v110, 2, s38
    v_lshrrev_b32 v113, 1, v111
    s_lshl_b32 s38, s37, 2
    v_add_u32 v113, s38, v113
    v_mul_u32_u24 v113, 1536, v113
    v_lshl_add_u32 v113, v110, 4, v113
    v_and_b32 v114, 1, v111
    v_lshl_add_u32 v113, v114, 3, v113
    s_mul_i32 s38, s36, 768
    s_add_u32 s38, s38, 94208
    v_add_u32 v144, s38, v113
    s_mul_i32 s38, s36, 48
    v_add_u32 v115, s38, v110
    v_lshrrev_b32 v116, 1, v115
    v_and_b32 v116, 7, v116
    v_lshrrev_b32 v117, 1, v111
    v_lshl_add_u32 v117, v114, 1, v117
    s_lshl_b32 s38, s37, 2
    v_add_u32 v117, s38, v117
    v_xor_b32 v117, v117, v116
    v_lshlrev_b32 v117, 4, v117
    v_lshl_add_u32 v145, v115, 7, v117
    v_lshlrev_b32 v110, 4, v107
    s_mul_i32 s38, s22, 3072
    v_add_u32 v146, s38, v110
    v_lshrrev_b32 v111, 3, v107
    s_mul_i32 s38, s20, 96
    s_mul_i32 s39, s22, 24
    s_add_u32 s38, s38, s39
    v_add_u32 v111, s38, v111
    v_mul_u32_u24 v111, 1280, v111
    s_lshl_b32 s38, s21, 7
    v_add_u32 v111, s38, v111
    s_mul_i32 s38, s22, 12
    s_add_u32 s38, s38, 0
    v_lshrrev_b32 v112, 4, v107
    v_add_u32 v112, s38, v112
    v_and_b32 v112, 7, v112
    v_and_b32 v113, 7, v107
    v_xor_b32 v112, v112, v113
    v_lshl_add_u32 v147, v112, 4, v111
    v_add_u32 v147, 0, v147
    s_mul_i32 s38, s22, 12
    s_add_u32 s38, s38, 4
    v_lshrrev_b32 v112, 4, v107
    v_add_u32 v112, s38, v112
    v_and_b32 v112, 7, v112
    v_and_b32 v113, 7, v107
    v_xor_b32 v112, v112, v113
    v_lshl_add_u32 v148, v112, 4, v111
    v_add_u32 v148, 10240, v148
    s_mul_i32 s38, s22, 12
    s_add_u32 s38, s38, 8
    v_lshrrev_b32 v112, 4, v107
    v_add_u32 v112, s38, v112
    v_and_b32 v112, 7, v112
    v_and_b32 v113, 7, v107
    v_xor_b32 v112, v112, v113
    v_lshl_add_u32 v149, v112, 4, v111
    v_add_u32 v149, 20480, v149
    v_mov_b32 v108, v104
    v_mov_b32 v109, v105
    v_mov_b32 v116, v106
    s_mov_b32 s40, 0
    s_mov_b32 s41, 0
    s_mov_b32 s43, 0
    s_cmp_eq_u32 s91, 0
    s_cbranch_scc1 L_fd_67
    s_waitcnt vmcnt(0)
    s_add_u32 s98, s98, 1
    s_lshl_b32 s99, s22, 2
    s_add_u32 s99, s99, 163712
    v_mov_b32 v164, s99
    v_mov_b32 v165, s98
    s_waitcnt lgkmcnt(0)
    ds_write_b32 v164, v165
    v_mov_b32 v164, 163712
L_csync_69:
    ds_read_b128 v[160:163], v164
    s_waitcnt lgkmcnt(0)
    v_min_u32 v160, v160, v161
    v_min_u32 v162, v162, v163
    v_min_u32 v160, v160, v162
    v_cmp_le_u32 vcc, v165, v160
    s_nop 0
    s_cbranch_vccz L_csync_69
    s_cmp_eq_u32 s22, 0
    s_cbranch_scc0 L_fd2_68
    s_sub_u32 s91, s91, 1
    s_add_u32 s92, s12, 23379968
    s_addc_u32 s93, s13, 0
    s_mov_b32 s94, 40960
    s_mov_b32 s95, 0x20000
    s_mov_b32 s99, s91
    s_lshl_b32 s99, s99, 7
    v_mov_b32 v160, s99
    v_mov_b32 v161, 1
    s_mov_b64 exec, 1
    buffer_atomic_add v161, v160, s[92:95], 0 offen sc1
    s_mov_b64 exec, -1
    v_mov_b32 v160, 163732
    v_mov_b32 v161, 3
    ds_write_b32 v160, v161
L_fd2_68:
    s_mov_b32 s91, 0
L_fd_67:
    s_barrier
    ds_read_b64_tr_b16 v[48:49], v105 offset:0
    ds_read_b64_tr_b16 v[50:51], v105 offset:512
    ds_read_b128 v[24:27], v104 offset:0
    ds_read_b64_tr_b16 v[52:53], v106 offset:0
    ds_read_b64_tr_b16 v[54:55], v106 offset:512
    ds_read_b128 v[28:31], v104 offset:256
    ds_read_b128 v[32:35], v104 offset:512
    ds_read_b64_tr_b16 v[56:57], v105 offset:4096
    ds_read_b64_tr_b16 v[58:59], v105 offset:4608
    ds_read_b128 v[36:39], v104 offset:6144
    ds_read_b64_tr_b16 v[60:61], v106 offset:4096
    ds_read_b64_tr_b16 v[62:63], v106 offset:4608
    ds_read_b128 v[40:43], v104 offset:6400
    ds_read_b128 v[44:47], v104 offset:6656
    s_add_u32 s40, s40, 1
    s_add_u32 s41, s41, 12288
    s_cmp_eq_u32 s41, 61440
    s_cselect_b32 s41, 0, s41
    s_add_u32 s43, s43, 8192
    s_cmp_eq_u32 s43, 98304
    s_cselect_b32 s43, 0, s43
    v_add_u32 v104, s41, v108
    v_add_u32 v105, s43, v109
    v_add_u32 v106, s43, v116
    s_cmp_eq_u32 s40, 37
L_k4_main_a:
    s_barrier
    s_waitcnt lgkmcnt(0)
    ds_read_b64_tr_b16 v[88:89], v105 offset:0
    ds_read_b64_tr_b16 v[90:91], v105 offset:512
    v_mfma_f32_16x16x32_bf16 v[168:171], v[48:51], v[24:27], v[168:171]
    ds_read_b128 v[64:67], v104 offset:0
    ds_read_b64_tr_b16 v[92:93], v106 offset:0
    v_mfma_f32_16x16x32_bf16 v[172:175], v[52:55], v[24:27], v[172:175]
    ds_read_b64_tr_b16 v[94:95], v106 offset:512
    ds_read_b128 v[68:71], v104 offset:256
    v_mfma_f32_16x16x32_bf16 v[176:179], v[48:51], v[28:31], v[176:179]
    ds_read_b128 v[72:75], v104 offset:512
    ds_read_b64_tr_b16 v[96:97], v105 offset:4096
    v_mfma_f32_16x16x32_bf16 v[180:183], v[52:55], v[28:31], v[180:183]
    ds_read_b64_tr_b16 v[98:99], v105 offset:4608
    ds_read_b128 v[76:79], v104 offset:6144
    v_mfma_f32_16x16x32_bf16 v[184:187], v[48:51], v[32:35], v[184:187]
    ds_read_b64_tr_b16 v[100:101], v106 offset:4096
    ds_read_b64_tr_b16 v[102:103], v106 offset:4608
    v_mfma_f32_16x16x32_bf16 v[188:191], v[52:55], v[32:35], v[188:191]
    ds_read_b128 v[80:83], v104 offset:6400
    ds_read_b128 v[84:87], v104 offset:6656
    v_mfma_f32_16x16x32_bf16 v[168:171], v[56:59], v[36:39], v[168:171]
    s_add_u32 s40, s40, 1
    s_add_u32 s41, s41, 12288
    s_cmp_eq_u32 s41, 61440
    v_mfma_f32_16x16x32_bf16 v[172:175], v[60:63], v[36:39], v[172:175]
    s_cselect_b32 s41, 0, s41
    s_add_u32 s43, s43, 8192
    s_cmp_eq_u32 s43, 98304
    v_mfma_f32_16x16x32_bf16 v[176:179], v[56:59], v[40:43], v[176:179]
    s_cselect_b32 s43, 0, s43
    v_add_u32 v104, s41, v108
    v_add_u32 v105, s43, v109
    v_mfma_f32_16x16x32_bf16 v[180:183], v[60:63], v[40:43], v[180:183]
    v_add_u32 v106, s43, v116
    s_cmp_eq_u32 s40, 37
    v_mfma_f32_16x16x32_bf16 v[184:187], v[56:59], v[44:47], v[184:187]
    v_mfma_f32_16x16x32_bf16 v[188:191], v[60:63], v[44:47], v[188:191]
    s_barrier
    s_waitcnt lgkmcnt(0)
    ds_read_b64_tr_b16 v[48:49], v105 offset:0
    ds_read_b64_tr_b16 v[50:51], v105 offset:512
    v_mfma_f32_16x16x32_bf16 v[168:171], v[88:91], v[64:67], v[168:171]
    ds_read_b128 v[24:27], v104 offset:0
    ds_read_b64_tr_b16 v[52:53], v106 offset:0
    v_mfma_f32_16x16x32_bf16 v[172:175], v[92:95], v[64:67], v[172:175]
    ds_read_b64_tr_b16 v[54:55], v106 offset:512
    ds_read_b128 v[28:31], v104 offset:256
    v_mfma_f32_16x16x32_bf16 v[176:179], v[88:91], v[68:71], v[176:179]
    ds_read_b128 v[32:35], v104 offset:512
    ds_read_b64_tr_b16 v[56:57], v105 offset:4096
    v_mfma_f32_16x16x32_bf16 v[180:183], v[92:95], v[68:71], v[180:183]
    ds_read_b64_tr_b16 v[58:59], v105 offset:4608
    ds_read_b128 v[36:39], v104 offset:6144
    v_mfma_f32_16x16x32_bf16 v[184:187], v[88:91], v[72:75], v[184:187]
    ds_read_b64_tr_b16 v[60:61], v106 offset:4096
    ds_read_b64_tr_b16 v[62:63], v106 offset:4608
    v_mfma_f32_16x16x32_bf16 v[188:191], v[92:95], v[72:75], v[188:191]
    ds_read_b128 v[40:43], v104 offset:6400
    ds_read_b128 v[44:47], v104 offset:6656
    v_mfma_f32_16x16x32_bf16 v[168:171], v[96:99], v[76:79], v[168:171]
    s_add_u32 s40, s40, 1
    s_add_u32 s41, s41, 12288
    s_cmp_eq_u32 s41, 61440
    v_mfma_f32_16x16x32_bf16 v[172:175], v[100:103], v[76:79], v[172:175]
    s_cselect_b32 s41, 0, s41
    s_add_u32 s43, s43, 8192
    s_cmp_eq_u32 s43, 98304
    v_mfma_f32_16x16x32_bf16 v[176:179], v[96:99], v[80:83], v[176:179]
    s_cselect_b32 s43, 0, s43
    v_add_u32 v104, s41, v108
    v_add_u32 v105, s43, v109
    v_mfma_f32_16x16x32_bf16 v[180:183], v[100:103], v[80:83], v[180:183]
    v_add_u32 v106, s43, v116
    s_cmp_eq_u32 s40, 37
    v_mfma_f32_16x16x32_bf16 v[184:187], v[96:99], v[84:87], v[184:187]
    v_mfma_f32_16x16x32_bf16 v[188:191], v[100:103], v[84:87], v[188:191]
    s_cmp_lt_u32 s40, 11
    s_cbranch_scc1 L_k4_main_a
    s_cmp_eq_u32 s40, 37
L_k4_main:
    s_cbranch_scc1 L_k4_last0
    s_barrier
    s_waitcnt lgkmcnt(0)
    ds_read_b64_tr_b16 v[88:89], v105 offset:0
    ds_read_b64_tr_b16 v[90:91], v105 offset:512
    v_mfma_f32_16x16x32_bf16 v[0:3], v[48:51], v[24:27], v[0:3]
    ds_read_b128 v[64:67], v104 offset:0
    ds_read_b64_tr_b16 v[92:93], v106 offset:0
    v_mfma_f32_16x16x32_bf16 v[4:7], v[52:55], v[24:27], v[4:7]
    ds_read_b64_tr_b16 v[94:95], v106 offset:512
    ds_read_b128 v[68:71], v104 offset:256
    v_mfma_f32_16x16x32_bf16 v[8:11], v[48:51], v[28:31], v[8:11]
    ds_read_b128 v[72:75], v104 offset:512
    ds_read_b64_tr_b16 v[96:97], v105 offset:4096
    v_mfma_f32_16x16x32_bf16 v[12:15], v[52:55], v[28:31], v[12:15]
    ds_read_b64_tr_b16 v[98:99], v105 offset:4608
    ds_read_b128 v[76:79], v104 offset:6144
    v_mfma_f32_16x16x32_bf16 v[16:19], v[48:51], v[32:35], v[16:19]
    ds_read_b64_tr_b16 v[100:101], v106 offset:4096
    ds_read_b64_tr_b16 v[102:103], v106 offset:4608
    v_mfma_f32_16x16x32_bf16 v[20:23], v[52:55], v[32:35], v[20:23]
    ds_read_b128 v[80:83], v104 offset:6400
    ds_read_b128 v[84:87], v104 offset:6656
    v_mfma_f32_16x16x32_bf16 v[0:3], v[56:59], v[36:39], v[0:3]
    s_add_u32 s40, s40, 1
    s_add_u32 s41, s41, 12288
    s_cmp_eq_u32 s41, 61440
    v_mfma_f32_16x16x32_bf16 v[4:7], v[60:63], v[36:39], v[4:7]
    s_cselect_b32 s41, 0, s41
    s_add_u32 s43, s43, 8192
    s_cmp_eq_u32 s43, 98304
    v_mfma_f32_16x16x32_bf16 v[8:11], v[56:59], v[40:43], v[8:11]
    s_cselect_b32 s43, 0, s43
    v_add_u32 v104, s41, v108
    v_add_u32 v105, s43, v109
    v_mfma_f32_16x16x32_bf16 v[12:15], v[60:63], v[40:43], v[12:15]
    v_add_u32 v106, s43, v116
    s_cmp_eq_u32 s40, 37
    v_mfma_f32_16x16x32_bf16 v[16:19], v[56:59], v[44:47], v[16:19]
    v_mfma_f32_16x16x32_bf16 v[20:23], v[60:63], v[44:47], v[20:23]
    s_cbranch_scc1 L_k4_last1
    s_barrier
    s_waitcnt lgkmcnt(0)
    ds_read_b64_tr_b16 v[48:49], v105 offset:0
    ds_read_b64_tr_b16 v[50:51], v105 offset:512
    v_mfma_f32_16x16x32_bf16 v[0:3], v[88:91], v[64:67], v[0:3]
    ds_read_b128 v[24:27], v104 offset:0
    ds_read_b64_tr_b16 v[52:53], v106 offset:0
    v_mfma_f32_16x16x32_bf16 v[4:7], v[92:95], v[64:67], v[4:7]
    ds_read_b64_tr_b16 v[54:55], v106 offset:512
    ds_read_b128 v[28:31], v104 offset:256
    v_mfma_f32_16x16x32_bf16 v[8:11], v[88:91], v[68:71], v[8:11]
    ds_read_b128 v[32:35], v104 offset:512
    ds_read_b64_tr_b16 v[56:57], v105 offset:4096
    v_mfma_f32_16x16x32_bf16 v[12:15], v[92:95], v[68:71], v[12:15]
    ds_read_b64_tr_b16 v[58:59], v105 offset:4608
    ds_read_b128 v[36:39], v104 offset:6144
    v_mfma_f32_16x16x32_bf16 v[16:19], v[88:91], v[72:75], v[16:19]
    ds_read_b64_tr_b16 v[60:61], v106 offset:4096
    ds_read_b64_tr_b16 v[62:63], v106 offset:4608
    v_mfma_f32_16x16x32_bf16 v[20:23], v[92:95], v[72:75], v[20:23]
    ds_read_b128 v[40:43], v104 offset:6400
    ds_read_b128 v[44:47], v104 offset:6656
    v_mfma_f32_16x16x32_bf16 v[0:3], v[96:99], v[76:79], v[0:3]
    s_add_u32 s40, s40, 1
    s_add_u32 s41, s41, 12288
    s_cmp_eq_u32 s41, 61440
    v_mfma_f32_16x16x32_bf16 v[4:7], v[100:103], v[76:79], v[4:7]
    s_cselect_b32 s41, 0, s41
    s_add_u32 s43, s43, 8192
    s_cmp_eq_u32 s43, 98304
    v_mfma_f32_16x16x32_bf16 v[8:11], v[96:99], v[80:83], v[8:11]
    s_cselect_b32 s43, 0, s43
    v_add_u32 v104, s41, v108
    v_add_u32 v105, s43, v109
    v_mfma_f32_16x16x32_bf16 v[12:15], v[100:103], v[80:83], v[12:15]
    v_add_u32 v106, s43, v116
    s_cmp_eq_u32 s40, 37
    v_mfma_f32_16x16x32_bf16 v[16:19], v[96:99], v[84:87], v[16:19]
    v_mfma_f32_16x16x32_bf16 v[20:23], v[100:103], v[84:87], v[20:23]
    s_branch L_k4_main
L_k4_last0:
    s_waitcnt lgkmcnt(0)
    v_mfma_f32_16x16x32_bf16 v[0:3], v[48:51], v[24:27], v[0:3]
    v_mfma_f32_16x16x32_bf16 v[4:7], v[52:55], v[24:27], v[4:7]
    v_mfma_f32_16x16x32_bf16 v[8:11], v[48:51], v[28:31], v[8:11]
    v_mfma_f32_16x16x32_bf16 v[12:15], v[52:55], v[28:31], v[12:15]
    v_mfma_f32_16x16x32_bf16 v[16:19], v[48:51], v[32:35], v[16:19]
    v_mfma_f32_16x16x32_bf16 v[20:23], v[52:55], v[32:35], v[20:23]
    v_mfma_f32_16x16x32_bf16 v[0:3], v[56:59], v[36:39], v[0:3]
    v_mfma_f32_16x16x32_bf16 v[4:7], v[60:63], v[36:39], v[4:7]
    v_mfma_f32_16x16x32_bf16 v[8:11], v[56:59], v[40:43], v[8:11]
    v_mfma_f32_16x16x32_bf16 v[12:15], v[60:63], v[40:43], v[12:15]
    v_mfma_f32_16x16x32_bf16 v[16:19], v[56:59], v[44:47], v[16:19]
    v_mfma_f32_16x16x32_bf16 v[20:23], v[60:63], v[44:47], v[20:23]
    s_branch L_k4_done
L_k4_last1:
    s_waitcnt lgkmcnt(0)
    v_mfma_f32_16x16x32_bf16 v[0:3], v[88:91], v[64:67], v[0:3]
    v_mfma_f32_16x16x32_bf16 v[4:7], v[92:95], v[64:67], v[4:7]
    v_mfma_f32_16x16x32_bf16 v[8:11], v[88:91], v[68:71], v[8:11]
    v_mfma_f32_16x16x32_bf16 v[12:15], v[92:95], v[68:71], v[12:15]
    v_mfma_f32_16x16x32_bf16 v[16:19], v[88:91], v[72:75], v[16:19]
    v_mfma_f32_16x16x32_bf16 v[20:23], v[92:95], v[72:75], v[20:23]
    v_mfma_f32_16x16x32_bf16 v[0:3], v[96:99], v[76:79], v[0:3]
    v_mfma_f32_16x16x32_bf16 v[4:7], v[100:103], v[76:79], v[4:7]
    v_mfma_f32_16x16x32_bf16 v[8:11], v[96:99], v[80:83], v[8:11]
    v_mfma_f32_16x16x32_bf16 v[12:15], v[100:103], v[80:83], v[12:15]
    v_mfma_f32_16x16x32_bf16 v[16:19], v[96:99], v[84:87], v[16:19]
    v_mfma_f32_16x16x32_bf16 v[20:23], v[100:103], v[84:87], v[20:23]
L_k4_done:
    s_barrier
    ds_read_b64 v[24:25], v144 offset:0
    ds_read_b64 v[26:27], v144 offset:3072
    ds_read_b32 v152, v150 offset:0
    ds_read_b64 v[28:29], v144 offset:256
    ds_read_b64 v[30:31], v144 offset:3328
    ds_read_b32 v154, v150 offset:64
    ds_read_b64 v[32:33], v144 offset:512
    ds_read_b64 v[34:35], v144 offset:3584
    ds_read_b32 v156, v150 offset:128
    s_waitcnt lgkmcnt(0)
    v_sub_f32 v153, 1.0, v152
    v_sub_f32 v155, 1.0, v154
    v_sub_f32 v157, 1.0, v156
    v_lshlrev_b32 v56, 16, v24
    v_and_b32 v57, 0xffff0000, v24
    v_lshlrev_b32 v58, 16, v25
    v_and_b32 v59, 0xffff0000, v25
    v_pk_add_f32 v[0:1], v[0:1], v[56:57]
    v_pk_add_f32 v[2:3], v[2:3], v[58:59]
    v_pk_mul_f32 v[168:169], v[168:169], v[152:153] op_sel_hi:[1,0]
    v_pk_mul_f32 v[170:171], v[170:171], v[152:153] op_sel_hi:[1,0]
    v_pk_fma_f32 v[0:1], v[0:1], v[152:153], v[168:169] op_sel:[0,1,0] op_sel_hi:[1,1,1]
    v_pk_fma_f32 v[2:3], v[2:3], v[152:153], v[170:171] op_sel:[0,1,0] op_sel_hi:[1,1,1]
    v_cvt_pk_bf16_f32 v48, v0, v1
    v_cvt_pk_bf16_f32 v49, v2, v3
    v_lshlrev_b32 v56, 16, v26
    v_and_b32 v57, 0xffff0000, v26
    v_lshlrev_b32 v58, 16, v27
    v_and_b32 v59, 0xffff0000, v27
    v_pk_add_f32 v[4:5], v[4:5], v[56:57]
    v_pk_add_f32 v[6:7], v[6:7], v[58:59]
    v_pk_mul_f32 v[172:173], v[172:173], v[152:153] op_sel_hi:[1,0]
    v_pk_mul_f32 v[174:175], v[174:175], v[152:153] op_sel_hi:[1,0]
    v_pk_fma_f32 v[4:5], v[4:5], v[152:153], v[172:173] op_sel:[0,1,0] op_sel_hi:[1,1,1]
    v_pk_fma_f32 v[6:7], v[6:7], v[152:153], v[174:175] op_sel:[0,1,0] op_sel_hi:[1,1,1]
    v_cvt_pk_bf16_f32 v50, v4, v5
    v_cvt_pk_bf16_f32 v51, v6, v7
    s_nop 1
    v_permlane16_swap_b32 v48, v50
    v_permlane16_swap_b32 v49, v51
    ds_write_b128 v145, v[48:51] offset:0
    v_lshlrev_b32 v56, 16, v28
    v_and_b32 v57, 0xffff0000, v28
    v_lshlrev_b32 v58, 16, v29
    v_and_b32 v59, 0xffff0000, v29
    v_pk_add_f32 v[8:9], v[8:9], v[56:57]
    v_pk_add_f32 v[10:11], v[10:11], v[58:59]
    v_pk_mul_f32 v[176:177], v[176:177], v[154:155] op_sel_hi:[1,0]
    v_pk_mul_f32 v[178:179], v[178:179], v[154:155] op_sel_hi:[1,0]
    v_pk_fma_f32 v[8:9], v[8:9], v[154:155], v[176:177] op_sel:[0,1,0] op_sel_hi:[1,1,1]
    v_pk_fma_f32 v[10:11], v[10:11], v[154:155], v[178:179] op_sel:[0,1,0] op_sel_hi:[1,1,1]
    v_cvt_pk_bf16_f32 v52, v8, v9
    v_cvt_pk_bf16_f32 v53, v10, v11
    v_lshlrev_b32 v56, 16, v30
    v_and_b32 v57, 0xffff0000, v30
    v_lshlrev_b32 v58, 16, v31
    v_and_b32 v59, 0xffff0000, v31
    v_pk_add_f32 v[12:13], v[12:13], v[56:57]
    v_pk_add_f32 v[14:15], v[14:15], v[58:59]
    v_pk_mul_f32 v[180:181], v[180:181], v[154:155] op_sel_hi:[1,0]
    v_pk_mul_f32 v[182:183], v[182:183], v[154:155] op_sel_hi:[1,0]
    v_pk_fma_f32 v[12:13], v[12:13], v[154:155], v[180:181] op_sel:[0,1,0] op_sel_hi:[1,1,1]
    v_pk_fma_f32 v[14:15], v[14:15], v[154:155], v[182:183] op_sel:[0,1,0] op_sel_hi:[1,1,1]
    v_cvt_pk_bf16_f32 v54, v12, v13
    v_cvt_pk_bf16_f32 v55, v14, v15
    s_nop 1
    v_permlane16_swap_b32 v52, v54
    v_permlane16_swap_b32 v53, v55
    ds_write_b128 v145, v[52:55] offset:2048
    v_lshlrev_b32 v56, 16, v32
    v_and_b32 v57, 0xffff0000, v32
    v_lshlrev_b32 v58, 16, v33
    v_and_b32 v59, 0xffff0000, v33
    v_pk_add_f32 v[16:17], v[16:17], v[56:57]
    v_pk_add_f32 v[18:19], v[18:19], v[58:59]
    v_pk_mul_f32 v[184:185], v[184:185], v[156:157] op_sel_hi:[1,0]
    v_pk_mul_f32 v[186:187], v[186:187], v[156:157] op_sel_hi:[1,0]
    v_pk_fma_f32 v[16:17], v[16:17], v[156:157], v[184:185] op_sel:[0,1,0] op_sel_hi:[1,1,1]
    v_pk_fma_f32 v[18:19], v[18:19], v[156:157], v[186:187] op_sel:[0,1,0] op_sel_hi:[1,1,1]
    v_cvt_pk_bf16_f32 v48, v16, v17
    v_cvt_pk_bf16_f32 v49, v18, v19
    v_lshlrev_b32 v56, 16, v34
    v_and_b32 v57, 0xffff0000, v34
    v_lshlrev_b32 v58, 16, v35
    v_and_b32 v59, 0xffff0000, v35
    v_pk_add_f32 v[20:21], v[20:21], v[56:57]
    v_pk_add_f32 v[22:23], v[22:23], v[58:59]
    v_pk_mul_f32 v[188:189], v[188:189], v[156:157] op_sel_hi:[1,0]
    v_pk_mul_f32 v[190:191], v[190:191], v[156:157] op_sel_hi:[1,0]
    v_pk_fma_f32 v[20:21], v[20:21], v[156:157], v[188:189] op_sel:[0,1,0] op_sel_hi:[1,1,1]
    v_pk_fma_f32 v[22:23], v[22:23], v[156:157], v[190:191] op_sel:[0,1,0] op_sel_hi:[1,1,1]
    v_cvt_pk_bf16_f32 v50, v20, v21
    v_cvt_pk_bf16_f32 v51, v22, v23
    s_nop 1
    v_permlane16_swap_b32 v48, v50
    v_permlane16_swap_b32 v49, v51
    ds_write_b128 v145, v[48:51] offset:4096
    s_waitcnt lgkmcnt(0)
    s_add_u32 s98, s98, 1
    s_lshl_b32 s99, s22, 2
    s_add_u32 s99, s99, 163712
    v_mov_b32 v164, s99
    v_mov_b32 v165, s98
    s_waitcnt lgkmcnt(0)
    ds_write_b32 v164, v165
    v_mov_b32 v164, 163712
L_csync_70:
    ds_read_b128 v[160:163], v164
    s_waitcnt lgkmcnt(0)
    v_min_u32 v160, v160, v161
    v_min_u32 v162, v162, v163
    v_min_u32 v160, v160, v162
    v_cmp_le_u32 vcc, v165, v160
    s_nop 0
    s_cbranch_vccz L_csync_70
    ds_read_b128 v[64:67], v146 offset:0
    ds_read_b128 v[68:71], v146 offset:1024
    ds_read_b128 v[72:75], v146 offset:2048
    s_waitcnt lgkmcnt(2)
    buffer_store_dwordx4 v[64:67], v147, s[56:59], 0 offen
    s_waitcnt lgkmcnt(1)
    buffer_store_dwordx4 v[68:71], v148, s[56:59], 0 offen
    s_waitcnt lgkmcnt(0)
    buffer_store_dwordx4 v[72:75], v149, s[56:59], 0 offen
    s_endpgm
L_k4_end:
    v_lshrrev_b32 v1, 6, v254
    s_nop 0
    v_readfirstlane_b32 s22, v1
    s_nop 3
    s_load_dwordx2 s[12:13], s[0:1], 88
    s_waitcnt lgkmcnt(0)
    s_cmp_eq_u32 s91, 0
    s_cbranch_scc1 L_fd_71
    s_waitcnt vmcnt(0)
    s_add_u32 s98, s98, 1
    s_lshl_b32 s99, s22, 2
    s_add_u32 s99, s99, 163712
    v_mov_b32 v164, s99
    v_mov_b32 v165, s98
    s_waitcnt lgkmcnt(0)
    ds_write_b32 v164, v165
    v_mov_b32 v164, 163712
L_csync_73:
    ds_read_b128 v[160:163], v164
    s_waitcnt lgkmcnt(0)
    v_min_u32 v160, v160, v161
    v_min_u32 v162, v162, v163
    v_min_u32 v160, v160, v162
    v_cmp_le_u32 vcc, v165, v160
    s_nop 0
    s_cbranch_vccz L_csync_73
    s_cmp_eq_u32 s22, 0
    s_cbranch_scc0 L_fd2_72
    s_sub_u32 s91, s91, 1
    s_add_u32 s92, s12, 23379968
    s_addc_u32 s93, s13, 0
    s_mov_b32 s94, 40960
    s_mov_b32 s95, 0x20000
    s_mov_b32 s99, s91
    s_lshl_b32 s99, s99, 7
    v_mov_b32 v160, s99
    v_mov_b32 v161, 1
    s_mov_b64 exec, 1
    buffer_atomic_add v161, v160, s[92:95], 0 offen sc1
    s_mov_b64 exec, -1
    v_mov_b32 v160, 163732
    v_mov_b32 v161, 3
    ds_write_b32 v160, v161
L_fd2_72:
    s_mov_b32 s91, 0
L_fd_71:
    s_endpgm
L_code_end:
.section .rodata,"a"
.p2align 6
.amdhsa_kernel gated_mix__linear_attn_block__mixer_s_mlp__prompt_kernel
  .amdhsa_next_free_vgpr 256
  .amdhsa_next_free_sgpr 100
  .amdhsa_accum_offset 256
  .amdhsa_group_segment_fixed_size 0
  .amdhsa_kernarg_size 96
  .amdhsa_user_sgpr_count 2
  .amdhsa_user_sgpr_kernarg_segment_ptr 1
  .amdhsa_system_sgpr_workgroup_id_x 1
.end_amdhsa_kernel
```
